```python
import torch

def _softmax(x, axis=-1):
    return torch.softmax(x, dim=axis)
def _gelu(x):
    return torch.nn.functional.gelu(x, approximate="tanh")
def _silu(x):
    return torch.nn.functional.silu(x)
def _sigmoid(x):
    return torch.sigmoid(x)
def _layernorm(x, axis=-1, eps=1e-5):
    m = x.mean(dim=axis, keepdim=True)
    v = x.var(dim=axis, keepdim=True, unbiased=False)
    return (x - m) / torch.sqrt(v + eps)
def _scatter_add(tgt, idx, src, axis=0):
    return tgt.clone().index_add_(axis, idx, src)
def _segment_sum(src, seg, n):
    out = torch.zeros((n,) + src.shape[1:], dtype=src.dtype)
    return out.index_add_(0, seg, src)
def _pad(x, pw):
    flat = tuple(v for pair in reversed(pw) for v in pair)
    return torch.nn.functional.pad(x, flat)

kernel_name = 'sequential_preLN__grouped_kv_mqa__geglu_ffn__prompt'

def setup_inputs():

    _w = (lambda a: (lambda t: t.to(torch.bfloat16) if t.is_floating_point() else t)(torch.as_tensor(a)))
    def _A_setup():
        B, S, D, H = 1, 2048, 512, 32
        Dh = D // H
        return {
            "x": _w((lambda *s: torch.randn(*s, dtype=torch.bfloat16) * 0.05)(B, S, D)),
            "wq": _w((lambda *s: torch.randn(*s, dtype=torch.bfloat16) * 0.05)(D, H * Dh)),
            "wk": _w((lambda *s: torch.randn(*s, dtype=torch.bfloat16) * 0.05)(D, Dh)),
            "wv": _w((lambda *s: torch.randn(*s, dtype=torch.bfloat16) * 0.05)(D, Dh)),
            "wo": _w((lambda *s: torch.randn(*s, dtype=torch.bfloat16) * 0.05)(H * Dh, D)),
        }
    _A_in = _A_setup()

    def _B_setup():
        B, S, D, F = 1, 2048, 512, 1376
        return {
            "x": _w((lambda *s: torch.randn(*s, dtype=torch.bfloat16) * 0.05)(B, S, D)),
            "w_gate": _w((lambda *s: torch.randn(*s, dtype=torch.bfloat16) * 0.05)(D, F)),
            "w_up": _w((lambda *s: torch.randn(*s, dtype=torch.bfloat16) * 0.05)(D, F)),
            "w_down": _w((lambda *s: torch.randn(*s, dtype=torch.bfloat16) * 0.05)(F, D)),
        }
    _B_in = _B_setup()

    return {
        "A_x": _A_in["x"],
        "A_wq": _A_in["wq"],
        "A_wk": _A_in["wk"],
        "A_wv": _A_in["wv"],
        "A_wo": _A_in["wo"],
        "B_x": _B_in["x"],
        "B_w_gate": _B_in["w_gate"],
        "B_w_up": _B_in["w_up"],
        "B_w_down": _B_in["w_down"],
    }

def reference(A_x, A_wq, A_wk, A_wv, A_wo, B_x, B_w_gate, B_w_up, B_w_down):
    def _A_ref(x, wq, wk, wv, wo):
        B, S, D = x.shape
        H = 32
        Dh = D // H
        q = (lambda x, *d: x.permute(*d))((x @ wq).reshape(B, S, H, Dh), 0, 2, 1, 3)
        k = x @ wk
        v = x @ wv
        scores = torch.einsum("bhqd,bkd->bhqk", q, k) * (Dh ** -0.5)
        p = _softmax(scores, axis=-1)
        o = torch.einsum("bhqk,bkd->bhqd", p, v)
        return (lambda x, *d: x.permute(*d))(o, 0, 2, 1, 3).reshape(B, S, H * Dh) @ wo

    def _B_ref(x, w_gate, w_up, w_down):
        return (_gelu(x @ w_gate) * (x @ w_up)) @ w_down

    x = A_x
    h = x + _A_ref(_layernorm(x, axis=-1), A_wq, A_wk, A_wv, A_wo)
    h2 = h + _B_ref(_layernorm(h, axis=-1), B_w_gate, B_w_up, B_w_down)
    return h2
```

```asm
; @launch grid=(256,1,1) block=(512,1,1) lds=163840
.amdgcn_target "amdgcn-amd-amdhsa--gfx950"
.text
.globl sequential_preLN__grouped_kv_mqa__geglu_ffn__prompt_kernel
.p2align 9
.p2align 8
.type sequential_preLN__grouped_kv_mqa__geglu_ffn__prompt_kernel,@function
sequential_preLN__grouped_kv_mqa__geglu_ffn__prompt_kernel:
    s_cmp_ge_u32 s2, 256
    s_cbranch_scc1 L_end
    s_load_dwordx16 s[4:19], s[0:1], 0
    s_load_dwordx8 s[20:27], s[0:1], 64
    v_lshrrev_b32 v3, 6, v0
    v_and_b32 v0, 63, v0
    s_and_b32 s51, s2, 7
    v_readfirstlane_b32 s48, v3
    s_lshr_b32 s52, s2, 3
    s_and_b32 s49, s52, 3
    s_lshl_b32 s57, s51, 2
    s_add_u32 s49, s49, s57
    s_lshr_b32 s50, s52, 2
    s_and_b32 s71, s50, 1
    v_lshlrev_b32 v1, 4, v0
    s_cmp_eq_u32 s48, 7
    s_cbranch_scc0 L_nopf
    s_getpc_b64 s[74:75]
L_pc:
    s_lshl_b32 s57, s50, 12
    v_lshl_add_u32 v4, v0, 6, s57
    v_min_u32 v4, L_end-L_pc, v4
    v_mov_b32 v5, s75
    v_add_co_u32 v4, vcc, s74, v4
    s_nop 1
    v_addc_co_u32 v5, vcc, 0, v5, vcc
    global_load_dword v251, v[4:5], off
L_nopf:
    s_cmp_ge_u32 s48, 4
    s_cbranch_scc1 L_g1_a
    v_lshrrev_b32 v3, 4, v0
    s_lshl_b32 s57, s48, 3
    v_add_u32 v3, s57, v3
    v_xor_b32 v4, v3, v0
    v_and_b32 v4, 15, v4
    v_lshlrev_b32 v4, 4, v4
    v_lshl_add_u32 v12, v3, 10, v4
    v_add_u32 v3, 4, v3
    v_xor_b32 v4, v3, v0
    v_and_b32 v4, 15, v4
    v_lshlrev_b32 v4, 4, v4
    v_lshl_add_u32 v13, v3, 10, v4
    s_lshl_b32 s58, s49, 16
    s_lshl_b32 s59, s71, 15
    s_add_u32 s72, s58, s59
    s_lshl_b32 s60, s48, 11
    s_lshl_b32 s61, s71, 13
    s_add_u32 s62, s60, s61
    s_waitcnt lgkmcnt(0)
    s_mov_b32 s32, s4
    s_mov_b32 s33, s5
    s_mov_b32 s34, 2097152
    s_mov_b32 s35, 0x20000
    s_mov_b32 m0, s62
    s_lshr_b32 s56, s48, 2
    buffer_load_dwordx4 v12, s[32:35], s72 offen offset:0 lds
    s_add_u32 m0, s62, 1024
    s_lshr_b32 s54, s48, 1
    buffer_load_dwordx4 v13, s[32:35], s72 offen offset:0 lds
    s_add_u32 m0, s62, 16128
    s_and_b32 s54, s54, 1
    buffer_load_dwordx4 v12, s[32:35], s72 offen offset:256 lds
    s_add_u32 m0, s62, 17152
    s_and_b32 s55, s48, 1
    buffer_load_dwordx4 v13, s[32:35], s72 offen offset:256 lds
    s_add_u32 m0, s62, 32256
    s_and_b32 s76, s48, 3
    buffer_load_dwordx4 v12, s[32:35], s72 offen offset:512 lds
    s_add_u32 m0, s62, 33280
    s_mov_b32 s64, 0
    buffer_load_dwordx4 v13, s[32:35], s72 offen offset:512 lds
    s_add_u32 m0, s62, 48384
    s_mov_b32 s65, -1
    buffer_load_dwordx4 v12, s[32:35], s72 offen offset:768 lds
    s_add_u32 m0, s62, 49408
    s_lshl_b32 s67, s49, 1
    buffer_load_dwordx4 v13, s[32:35], s72 offen offset:768 lds
    s_cmp_ge_u32 s50, 4
    s_cbranch_scc1 L_a_nokv
    s_lshl_b32 s60, s48, 12
    s_add_u32 m0, s60, 131072
    s_cmp_ge_u32 s50, 2
    s_cselect_b32 s40, s10, s8
    s_cselect_b32 s41, s11, s9
    s_mov_b32 s42, 16384
    s_mov_b32 s43, 0x20000
    buffer_load_dwordx4 v1, s[40:43], s60 offen offset:0 lds
    buffer_load_dwordx4 v1, s[40:43], s60 offen offset:1024 lds
    buffer_load_dwordx4 v1, s[40:43], s60 offen offset:2048 lds
    buffer_load_dwordx4 v1, s[40:43], s60 offen offset:3072 lds
L_a_nokv:
    s_add_u32 s67, s67, s54
    s_mov_b32 s66, 0x3f803f80
    v_lshrrev_b32 v3, 2, v0
    v_and_b32 v3, 4, v3
    v_and_b32 v4, 7, v0
    v_xor_b32 v4, v4, v3
    v_lshlrev_b32 v4, 4, v4
    v_lshrrev_b32 v3, 3, v0
    v_lshl_add_u32 v2, v3, 10, v4
    s_mov_b32 s28, s26
    s_mov_b32 s29, s27
    s_mov_b32 s30, 16777216
    s_mov_b32 s31, 0x20000
    s_mov_b32 s36, s6
    s_mov_b32 s37, s7
    s_mov_b32 s38, 524288
    s_mov_b32 s39, 0x20000
    s_xor_b32 s59, s59, 0x8000
    s_add_u32 s73, s58, s59
    s_lshl_b32 s60, s48, 11
    s_lshl_b32 s61, s71, 13
    s_xor_b32 s61, s61, 0x2000
    s_add_u32 s63, s60, s61
    s_lshl_b32 s72, s48, 15
    s_lshl_b32 s57, s50, 7
    s_add_u32 s72, s72, s57
    s_lshl_b32 s60, s48, 12
    s_mov_b32 s78, s63
    s_add_u32 m0, s78, 0
    s_add_u32 s61, s73, 0
    buffer_load_dwordx4 v12, s[32:35], s61 offen lds
    s_add_u32 m0, s78, 1024
    s_add_u32 s61, s73, 0
    buffer_load_dwordx4 v13, s[32:35], s61 offen lds
    s_add_u32 m0, s60, 65536
    s_add_u32 s61, s72, 0
    buffer_load_dwordx4 v2, s[36:39], s61 offen lds
    s_add_u32 m0, s60, 66560
    s_add_u32 s61, s72, 8192
    buffer_load_dwordx4 v2, s[36:39], s61 offen lds
    s_add_u32 m0, s60, 67584
    s_add_u32 s61, s72, 16384
    buffer_load_dwordx4 v2, s[36:39], s61 offen lds
    s_add_u32 m0, s60, 68608
    s_add_u32 s61, s72, 24576
    buffer_load_dwordx4 v2, s[36:39], s61 offen lds
    s_waitcnt vmcnt(6)
    s_barrier
    s_add_u32 m0, s78, 16384
    s_add_u32 s61, s73, 256
    buffer_load_dwordx4 v12, s[32:35], s61 offen lds
    s_add_u32 m0, s78, 17408
    s_add_u32 s61, s73, 256
    buffer_load_dwordx4 v13, s[32:35], s61 offen lds
    s_add_u32 m0, s60, 81920
    s_add_u32 s61, s72, 131072
    buffer_load_dwordx4 v2, s[36:39], s61 offen lds
    v_and_b32 v3, 31, v0
    s_lshl_b32 s57, s54, 5
    v_add_u32 v3, s57, v3
    v_lshrrev_b32 v208, 5, v0
    v_xor_b32 v208, v208, v0
    v_and_b32 v208, 15, v208
    v_lshlrev_b32 v208, 4, v208
    v_lshl_add_u32 v208, v3, 8, v208
    v_xor_b32 v209, 32, v208
    v_xor_b32 v210, 64, v208
    v_xor_b32 v211, 96, v208
    v_xor_b32 v212, 128, v208
    v_xor_b32 v213, 160, v208
    v_xor_b32 v214, 192, v208
    v_xor_b32 v215, 224, v208
    v_and_b32 v238, 15, v0
    v_lshrrev_b32 v216, 2, v238
    v_lshrrev_b32 v239, 5, v0
    v_mul_u32_u24 v239, 8, v239
    v_add_u32 v216, v216, v239
    v_lshlrev_b32 v216, 7, v216
    v_and_b32 v239, 3, v238
    v_lshlrev_b32 v239, 3, v239
    v_and_b32 v238, 8, v238
    v_lshlrev_b32 v238, 3, v238
    s_lshl_b32 s57, s55, 6
    v_xor_b32 v238, s57, v238
    v_add_u32 v238, v238, v239
    v_and_b32 v239, 16, v0
    v_lshl_add_u32 v238, v239, 1, v238
    v_add_u32 v216, v216, v238
    v_add_u32 v216, 65536, v216
    v_mov_b32 v160, 0
    v_mov_b32 v161, 0
    v_mov_b32 v162, 0
    v_mov_b32 v163, 0
    v_mov_b32 v164, 0
    v_mov_b32 v165, 0
    v_mov_b32 v166, 0
    v_mov_b32 v167, 0
    v_mov_b32 v168, 0
    v_mov_b32 v169, 0
    v_mov_b32 v170, 0
    v_mov_b32 v171, 0
    v_mov_b32 v172, 0
    v_mov_b32 v173, 0
    v_mov_b32 v174, 0
    v_mov_b32 v175, 0
    v_mov_b32 v217, 0
    v_mov_b32 v218, 0
    v_mov_b32 v20, 0
    v_mov_b32 v21, 0
    v_mov_b32 v22, 0
    v_mov_b32 v23, 0
    v_mov_b32 v24, 0
    v_mov_b32 v25, 0
    v_mov_b32 v26, 0
    v_mov_b32 v27, 0
    v_mov_b32 v28, 0
    v_mov_b32 v29, 0
    v_mov_b32 v30, 0
    v_mov_b32 v31, 0
    v_mov_b32 v32, 0
    v_mov_b32 v33, 0
    v_mov_b32 v34, 0
    v_mov_b32 v35, 0
    v_mov_b32 v36, 0
    v_mov_b32 v37, 0
    v_mov_b32 v38, 0
    v_mov_b32 v39, 0
    v_mov_b32 v40, 0
    v_mov_b32 v41, 0
    v_mov_b32 v42, 0
    v_mov_b32 v43, 0
    v_mov_b32 v44, 0
    v_mov_b32 v45, 0
    v_mov_b32 v46, 0
    v_mov_b32 v47, 0
    v_mov_b32 v48, 0
    v_mov_b32 v49, 0
    v_mov_b32 v50, 0
    v_mov_b32 v51, 0
    v_mov_b32 v155, 0
    v_mov_b32 v156, 0
    v_and_b32 v3, 31, v0
    s_lshl_b32 s57, s54, 5
    v_add_u32 v3, s57, v3
    v_lshlrev_b32 v238, 8, v3
    s_lshr_b32 s57, s50, 1
    s_lshl_b32 s57, s57, 14
    v_add_u32 v238, s57, v238
    v_lshrrev_b32 v239, 5, v0
    v_lshl_add_u32 v238, v239, 3, v238
    s_and_b32 s57, s50, 1
    s_lshl_b32 s57, s57, 3
    s_lshl_b32 s58, s55, 2
    s_add_u32 s57, s57, s58
    v_and_b32 v3, 15, v3
    v_xor_b32 v3, s57, v3
    v_xor_b32 v239, 0, v3
    v_lshl_add_u32 v240, v239, 4, v238
    v_xor_b32 v239, 1, v3
    v_lshl_add_u32 v241, v239, 4, v238
    v_xor_b32 v239, 2, v3
    v_lshl_add_u32 v242, v239, 4, v238
    v_xor_b32 v239, 3, v3
    v_lshl_add_u32 v243, v239, 4, v238
    s_waitcnt vmcnt(3)
    v_mov_b32 v246, 163092
    v_mov_b32 v247, 1
    s_mov_b64 exec, 1
    ds_add_u32 v246, v247
    s_mov_b64 exec, -1
    v_mov_b32 v246, 163096
    s_mov_b32 s70, 400000
L_quiet_1:
    ds_read_b32 v247, v246
    s_sub_u32 s70, s70, 1
    s_cbranch_scc1 L_quiet_1_x
    s_waitcnt lgkmcnt(0)
    v_readfirstlane_b32 s63, v247
    s_cmp_ge_u32 s63, 4
    s_cbranch_scc0 L_quiet_1
L_quiet_1_x:
    s_waitcnt lgkmcnt(0)
    s_add_u32 m0, s60, 82944
    s_add_u32 s61, s72, 139264
    buffer_load_dwordx4 v2, s[36:39], s61 offen lds
    s_add_u32 m0, s60, 83968
    s_add_u32 s61, s72, 147456
    buffer_load_dwordx4 v2, s[36:39], s61 offen lds
    s_add_u32 m0, s60, 84992
    s_add_u32 s61, s72, 155648
    buffer_load_dwordx4 v2, s[36:39], s61 offen lds
    v_mov_b32 v246, 163092
    s_mov_b32 s70, 400000
L_dma0_2:
    ds_read_b32 v247, v246
    s_sub_u32 s70, s70, 1
    s_cbranch_scc1 L_dma0_2_x
    s_waitcnt lgkmcnt(0)
    v_readfirstlane_b32 s63, v247
    s_cmp_ge_u32 s63, 4
    s_cbranch_scc0 L_dma0_2
L_dma0_2_x:
    s_waitcnt lgkmcnt(0)
    v_mov_b32 v245, 163092
    ds_read_b128 v[176:179], v208 offset:0
    ds_read_b64_tr_b16 v[192:193], v216 offset:0
    ds_read_b64_tr_b16 v[194:195], v216 offset:512
    ds_read_b128 v[180:183], v209 offset:0
    ds_read_b64_tr_b16 v[196:197], v216 offset:2048
    ds_read_b64_tr_b16 v[198:199], v216 offset:2560
    ds_read_b128 v[184:187], v210 offset:0
    ds_read_b64_tr_b16 v[200:201], v216 offset:4096
    ds_read_b64_tr_b16 v[202:203], v216 offset:4608
    s_waitcnt lgkmcnt(6)
    v_mfma_f32_32x32x16_bf16 v[160:175], v[192:195], v[176:179], v[160:175]
    ds_read_b128 v[188:191], v211 offset:0
    ds_read_b64_tr_b16 v[204:205], v216 offset:6144
    ds_read_b64_tr_b16 v[206:207], v216 offset:6656
    s_add_u32 m0, s78, 32768
    s_add_u32 s61, s73, 512
    buffer_load_dwordx4 v12, s[32:35], s61 offen lds
    s_waitcnt lgkmcnt(6)
    v_mfma_f32_32x32x16_bf16 v[160:175], v[196:199], v[180:183], v[160:175]
    v_dot2c_f32_bf16 v217, s66, v192
    v_dot2c_f32_bf16 v218, s66, v193
    v_dot2c_f32_bf16 v217, s66, v194
    v_dot2c_f32_bf16 v218, s66, v195
    ds_read_b128 v[176:179], v212 offset:0
    ds_read_b64_tr_b16 v[192:193], v216 offset:8192
    ds_read_b64_tr_b16 v[194:195], v216 offset:8704
    s_add_u32 m0, s78, 33792
    s_add_u32 s61, s73, 512
    buffer_load_dwordx4 v13, s[32:35], s61 offen lds
    v_dot2c_f32_bf16 v217, s66, v196
    v_dot2c_f32_bf16 v218, s66, v197
    v_dot2c_f32_bf16 v217, s66, v198
    v_dot2c_f32_bf16 v218, s66, v199
    s_waitcnt lgkmcnt(6)
    v_mfma_f32_32x32x16_bf16 v[160:175], v[200:203], v[184:187], v[160:175]
    ds_read_b128 v[180:183], v213 offset:0
    ds_read_b64_tr_b16 v[196:197], v216 offset:10240
    ds_read_b64_tr_b16 v[198:199], v216 offset:10752
    s_add_u32 m0, s78, 49152
    s_add_u32 s61, s73, 768
    buffer_load_dwordx4 v12, s[32:35], s61 offen lds
    s_waitcnt lgkmcnt(6)
    v_mfma_f32_32x32x16_bf16 v[160:175], v[204:207], v[188:191], v[160:175]
    v_dot2c_f32_bf16 v217, s66, v200
    v_dot2c_f32_bf16 v218, s66, v201
    v_dot2c_f32_bf16 v217, s66, v202
    v_dot2c_f32_bf16 v218, s66, v203
    ds_read_b128 v[184:187], v214 offset:0
    ds_read_b64_tr_b16 v[200:201], v216 offset:12288
    ds_read_b64_tr_b16 v[202:203], v216 offset:12800
    s_add_u32 m0, s78, 50176
    s_add_u32 s61, s73, 768
    buffer_load_dwordx4 v13, s[32:35], s61 offen lds
    v_dot2c_f32_bf16 v217, s66, v204
    v_dot2c_f32_bf16 v218, s66, v205
    v_dot2c_f32_bf16 v217, s66, v206
    v_dot2c_f32_bf16 v218, s66, v207
    s_waitcnt vmcnt(4)
    v_mov_b32 v246, 163092
    v_mov_b32 v247, 1
    s_mov_b64 exec, 1
    ds_add_u32 v246, v247
    s_mov_b64 exec, -1
    s_waitcnt lgkmcnt(7)
    v_mfma_f32_32x32x16_bf16 v[160:175], v[192:195], v[176:179], v[160:175]
    ds_read_b32 v244, v245
    ds_read_b128 v[188:191], v215 offset:0
    ds_read_b64_tr_b16 v[204:205], v216 offset:14336
    ds_read_b64_tr_b16 v[206:207], v216 offset:14848
    s_add_u32 m0, s60, 98304
    s_add_u32 s61, s72, 262144
    buffer_load_dwordx4 v2, s[36:39], s61 offen lds
    s_waitcnt lgkmcnt(8)
    v_mfma_f32_32x32x16_bf16 v[160:175], v[196:199], v[180:183], v[160:175]
    v_dot2c_f32_bf16 v217, s66, v192
    v_dot2c_f32_bf16 v218, s66, v193
    v_dot2c_f32_bf16 v217, s66, v194
    v_dot2c_f32_bf16 v218, s66, v195
    s_waitcnt lgkmcnt(3)
    v_readfirstlane_b32 s63, v244
    s_cmp_ge_u32 s63, 8
    s_cbranch_scc1 L_qpk_3
    s_mov_b32 s70, 400000
L_dma1_4:
    ds_read_b32 v244, v245
    s_sub_u32 s70, s70, 1
    s_cbranch_scc1 L_dma1_4_x
    s_waitcnt lgkmcnt(0)
    v_readfirstlane_b32 s63, v244
    s_cmp_ge_u32 s63, 8
    s_cbranch_scc0 L_dma1_4
L_dma1_4_x:
    s_waitcnt lgkmcnt(0)
L_qpk_3:
    ds_read_b128 v[176:179], v208 offset:16384
    ds_read_b64_tr_b16 v[192:193], v216 offset:16384
    ds_read_b64_tr_b16 v[194:195], v216 offset:16896
    s_add_u32 m0, s60, 99328
    s_add_u32 s61, s72, 270336
    buffer_load_dwordx4 v2, s[36:39], s61 offen lds
    v_dot2c_f32_bf16 v217, s66, v196
    v_dot2c_f32_bf16 v218, s66, v197
    v_dot2c_f32_bf16 v217, s66, v198
    v_dot2c_f32_bf16 v218, s66, v199
    s_waitcnt lgkmcnt(8)
    v_mfma_f32_32x32x16_bf16 v[160:175], v[200:203], v[184:187], v[160:175]
    ds_read_b128 v[180:183], v209 offset:16384
    ds_read_b64_tr_b16 v[196:197], v216 offset:18432
    ds_read_b64_tr_b16 v[198:199], v216 offset:18944
    s_add_u32 m0, s60, 100352
    s_add_u32 s61, s72, 278528
    buffer_load_dwordx4 v2, s[36:39], s61 offen lds
    s_waitcnt lgkmcnt(6)
    v_mfma_f32_32x32x16_bf16 v[160:175], v[204:207], v[188:191], v[160:175]
    v_dot2c_f32_bf16 v217, s66, v200
    v_dot2c_f32_bf16 v218, s66, v201
    v_dot2c_f32_bf16 v217, s66, v202
    v_dot2c_f32_bf16 v218, s66, v203
    ds_read_b128 v[184:187], v210 offset:16384
    ds_read_b64_tr_b16 v[200:201], v216 offset:20480
    ds_read_b64_tr_b16 v[202:203], v216 offset:20992
    s_add_u32 m0, s60, 101376
    s_add_u32 s61, s72, 286720
    buffer_load_dwordx4 v2, s[36:39], s61 offen lds
    v_dot2c_f32_bf16 v217, s66, v204
    v_dot2c_f32_bf16 v218, s66, v205
    v_dot2c_f32_bf16 v217, s66, v206
    v_dot2c_f32_bf16 v218, s66, v207
    s_waitcnt lgkmcnt(6)
    v_mfma_f32_32x32x16_bf16 v[160:175], v[192:195], v[176:179], v[160:175]
    ds_read_b128 v[188:191], v211 offset:16384
    ds_read_b64_tr_b16 v[204:205], v216 offset:22528
    ds_read_b64_tr_b16 v[206:207], v216 offset:23040
    s_add_u32 m0, s60, 114688
    s_add_u32 s61, s72, 393216
    buffer_load_dwordx4 v2, s[36:39], s61 offen lds
    s_waitcnt lgkmcnt(6)
    v_mfma_f32_32x32x16_bf16 v[160:175], v[196:199], v[180:183], v[160:175]
    v_dot2c_f32_bf16 v217, s66, v192
    v_dot2c_f32_bf16 v218, s66, v193
    v_dot2c_f32_bf16 v217, s66, v194
    v_dot2c_f32_bf16 v218, s66, v195
    ds_read_b128 v[176:179], v212 offset:16384
    ds_read_b64_tr_b16 v[192:193], v216 offset:24576
    ds_read_b64_tr_b16 v[194:195], v216 offset:25088
    s_add_u32 m0, s60, 115712
    s_add_u32 s61, s72, 401408
    buffer_load_dwordx4 v2, s[36:39], s61 offen lds
    v_dot2c_f32_bf16 v217, s66, v196
    v_dot2c_f32_bf16 v218, s66, v197
    v_dot2c_f32_bf16 v217, s66, v198
    v_dot2c_f32_bf16 v218, s66, v199
    s_waitcnt lgkmcnt(6)
    v_mfma_f32_32x32x16_bf16 v[160:175], v[200:203], v[184:187], v[160:175]
    ds_read_b128 v[180:183], v213 offset:16384
    ds_read_b64_tr_b16 v[196:197], v216 offset:26624
    ds_read_b64_tr_b16 v[198:199], v216 offset:27136
    s_add_u32 m0, s60, 116736
    s_add_u32 s61, s72, 409600
    buffer_load_dwordx4 v2, s[36:39], s61 offen lds
    s_waitcnt lgkmcnt(6)
    v_mfma_f32_32x32x16_bf16 v[160:175], v[204:207], v[188:191], v[160:175]
    v_dot2c_f32_bf16 v217, s66, v200
    v_dot2c_f32_bf16 v218, s66, v201
    v_dot2c_f32_bf16 v217, s66, v202
    v_dot2c_f32_bf16 v218, s66, v203
    ds_read_b128 v[184:187], v214 offset:16384
    ds_read_b64_tr_b16 v[200:201], v216 offset:28672
    ds_read_b64_tr_b16 v[202:203], v216 offset:29184
    s_add_u32 m0, s60, 117760
    s_add_u32 s61, s72, 417792
    buffer_load_dwordx4 v2, s[36:39], s61 offen lds
    v_dot2c_f32_bf16 v217, s66, v204
    v_dot2c_f32_bf16 v218, s66, v205
    v_dot2c_f32_bf16 v217, s66, v206
    v_dot2c_f32_bf16 v218, s66, v207
    s_waitcnt vmcnt(4)
    v_mov_b32 v246, 163092
    v_mov_b32 v247, 1
    s_mov_b64 exec, 1
    ds_add_u32 v246, v247
    s_mov_b64 exec, -1
    s_waitcnt lgkmcnt(7)
    v_mfma_f32_32x32x16_bf16 v[160:175], v[192:195], v[176:179], v[160:175]
    ds_read_b32 v244, v245
    ds_read_b128 v[188:191], v215 offset:16384
    ds_read_b64_tr_b16 v[204:205], v216 offset:30720
    ds_read_b64_tr_b16 v[206:207], v216 offset:31232
    s_waitcnt lgkmcnt(8)
    v_mfma_f32_32x32x16_bf16 v[160:175], v[196:199], v[180:183], v[160:175]
    v_dot2c_f32_bf16 v217, s66, v192
    v_dot2c_f32_bf16 v218, s66, v193
    v_dot2c_f32_bf16 v217, s66, v194
    v_dot2c_f32_bf16 v218, s66, v195
    s_waitcnt lgkmcnt(3)
    v_readfirstlane_b32 s63, v244
    s_cmp_ge_u32 s63, 12
    s_cbranch_scc1 L_qpk_5
    s_mov_b32 s70, 400000
L_dma2_6:
    ds_read_b32 v244, v245
    s_sub_u32 s70, s70, 1
    s_cbranch_scc1 L_dma2_6_x
    s_waitcnt lgkmcnt(0)
    v_readfirstlane_b32 s63, v244
    s_cmp_ge_u32 s63, 12
    s_cbranch_scc0 L_dma2_6
L_dma2_6_x:
    s_waitcnt lgkmcnt(0)
L_qpk_5:
    ds_read_b64 v[4:5], v240
    ds_read_b64 v[6:7], v241
    ds_read_b64 v[8:9], v242
    ds_read_b64 v[10:11], v243
    ds_read_b128 v[176:179], v208 offset:32768
    ds_read_b64_tr_b16 v[192:193], v216 offset:32768
    ds_read_b64_tr_b16 v[194:195], v216 offset:33280
    v_dot2c_f32_bf16 v217, s66, v196
    v_dot2c_f32_bf16 v218, s66, v197
    v_dot2c_f32_bf16 v217, s66, v198
    v_dot2c_f32_bf16 v218, s66, v199
    s_waitcnt lgkmcnt(12)
    v_mfma_f32_32x32x16_bf16 v[160:175], v[200:203], v[184:187], v[160:175]
    ds_read_b128 v[180:183], v209 offset:32768
    ds_read_b64_tr_b16 v[196:197], v216 offset:34816
    ds_read_b64_tr_b16 v[198:199], v216 offset:35328
    s_waitcnt lgkmcnt(10)
    v_mfma_f32_32x32x16_bf16 v[160:175], v[204:207], v[188:191], v[160:175]
    v_dot2c_f32_bf16 v217, s66, v200
    v_dot2c_f32_bf16 v218, s66, v201
    v_dot2c_f32_bf16 v217, s66, v202
    v_dot2c_f32_bf16 v218, s66, v203
    ds_read_b128 v[184:187], v210 offset:32768
    ds_read_b64_tr_b16 v[200:201], v216 offset:36864
    ds_read_b64_tr_b16 v[202:203], v216 offset:37376
    v_dot2c_f32_bf16 v217, s66, v204
    v_dot2c_f32_bf16 v218, s66, v205
    v_dot2c_f32_bf16 v217, s66, v206
    v_dot2c_f32_bf16 v218, s66, v207
    s_waitcnt lgkmcnt(6)
    v_mfma_f32_32x32x16_bf16 v[160:175], v[192:195], v[176:179], v[160:175]
    ds_read_b128 v[188:191], v211 offset:32768
    ds_read_b64_tr_b16 v[204:205], v216 offset:38912
    ds_read_b64_tr_b16 v[206:207], v216 offset:39424
    s_waitcnt lgkmcnt(6)
    v_mfma_f32_32x32x16_bf16 v[160:175], v[196:199], v[180:183], v[160:175]
    v_dot2c_f32_bf16 v217, s66, v192
    v_dot2c_f32_bf16 v218, s66, v193
    v_dot2c_f32_bf16 v217, s66, v194
    v_dot2c_f32_bf16 v218, s66, v195
    ds_read_b128 v[176:179], v212 offset:32768
    ds_read_b64_tr_b16 v[192:193], v216 offset:40960
    ds_read_b64_tr_b16 v[194:195], v216 offset:41472
    v_dot2c_f32_bf16 v217, s66, v196
    v_dot2c_f32_bf16 v218, s66, v197
    v_dot2c_f32_bf16 v217, s66, v198
    v_dot2c_f32_bf16 v218, s66, v199
    s_waitcnt lgkmcnt(6)
    v_mfma_f32_32x32x16_bf16 v[160:175], v[200:203], v[184:187], v[160:175]
    ds_read_b128 v[180:183], v213 offset:32768
    ds_read_b64_tr_b16 v[196:197], v216 offset:43008
    ds_read_b64_tr_b16 v[198:199], v216 offset:43520
    s_waitcnt lgkmcnt(6)
    v_mfma_f32_32x32x16_bf16 v[160:175], v[204:207], v[188:191], v[160:175]
    v_dot2c_f32_bf16 v217, s66, v200
    v_dot2c_f32_bf16 v218, s66, v201
    v_dot2c_f32_bf16 v217, s66, v202
    v_dot2c_f32_bf16 v218, s66, v203
    ds_read_b128 v[184:187], v214 offset:32768
    ds_read_b64_tr_b16 v[200:201], v216 offset:45056
    ds_read_b64_tr_b16 v[202:203], v216 offset:45568
    v_dot2c_f32_bf16 v217, s66, v204
    v_dot2c_f32_bf16 v218, s66, v205
    v_dot2c_f32_bf16 v217, s66, v206
    v_dot2c_f32_bf16 v218, s66, v207
    s_waitcnt vmcnt(0)
    v_mov_b32 v246, 163092
    v_mov_b32 v247, 1
    s_mov_b64 exec, 1
    ds_add_u32 v246, v247
    s_mov_b64 exec, -1
    s_waitcnt lgkmcnt(7)
    v_mfma_f32_32x32x16_bf16 v[160:175], v[192:195], v[176:179], v[160:175]
    ds_read_b32 v244, v245
    ds_read_b128 v[188:191], v215 offset:32768
    ds_read_b64_tr_b16 v[204:205], v216 offset:47104
    ds_read_b64_tr_b16 v[206:207], v216 offset:47616
    s_waitcnt lgkmcnt(8)
    v_mfma_f32_32x32x16_bf16 v[160:175], v[196:199], v[180:183], v[160:175]
    v_dot2c_f32_bf16 v217, s66, v192
    v_dot2c_f32_bf16 v218, s66, v193
    v_dot2c_f32_bf16 v217, s66, v194
    v_dot2c_f32_bf16 v218, s66, v195
    s_waitcnt lgkmcnt(3)
    v_readfirstlane_b32 s63, v244
    s_cmp_ge_u32 s63, 16
    s_cbranch_scc1 L_qpk_7
    s_mov_b32 s70, 400000
L_dma3_8:
    ds_read_b32 v244, v245
    s_sub_u32 s70, s70, 1
    s_cbranch_scc1 L_dma3_8_x
    s_waitcnt lgkmcnt(0)
    v_readfirstlane_b32 s63, v244
    s_cmp_ge_u32 s63, 16
    s_cbranch_scc0 L_dma3_8
L_dma3_8_x:
    s_waitcnt lgkmcnt(0)
L_qpk_7:
    ds_read_b128 v[176:179], v208 offset:49152
    ds_read_b64_tr_b16 v[192:193], v216 offset:49152
    ds_read_b64_tr_b16 v[194:195], v216 offset:49664
    v_dot2c_f32_bf16 v217, s66, v196
    v_dot2c_f32_bf16 v218, s66, v197
    v_dot2c_f32_bf16 v217, s66, v198
    v_dot2c_f32_bf16 v218, s66, v199
    s_waitcnt lgkmcnt(8)
    v_mfma_f32_32x32x16_bf16 v[160:175], v[200:203], v[184:187], v[160:175]
    ds_read_b128 v[180:183], v209 offset:49152
    ds_read_b64_tr_b16 v[196:197], v216 offset:51200
    ds_read_b64_tr_b16 v[198:199], v216 offset:51712
    s_waitcnt lgkmcnt(6)
    v_mfma_f32_32x32x16_bf16 v[160:175], v[204:207], v[188:191], v[160:175]
    v_dot2c_f32_bf16 v217, s66, v200
    v_dot2c_f32_bf16 v218, s66, v201
    v_dot2c_f32_bf16 v217, s66, v202
    v_dot2c_f32_bf16 v218, s66, v203
    ds_read_b128 v[184:187], v210 offset:49152
    ds_read_b64_tr_b16 v[200:201], v216 offset:53248
    ds_read_b64_tr_b16 v[202:203], v216 offset:53760
    v_dot2c_f32_bf16 v217, s66, v204
    v_dot2c_f32_bf16 v218, s66, v205
    v_dot2c_f32_bf16 v217, s66, v206
    v_dot2c_f32_bf16 v218, s66, v207
    s_waitcnt lgkmcnt(6)
    v_mfma_f32_32x32x16_bf16 v[160:175], v[192:195], v[176:179], v[160:175]
    ds_read_b128 v[188:191], v211 offset:49152
    ds_read_b64_tr_b16 v[204:205], v216 offset:55296
    ds_read_b64_tr_b16 v[206:207], v216 offset:55808
    v_mov_b32 v246, 163092
    v_mov_b32 v247, 1
    s_mov_b64 exec, 1
    ds_add_u32 v246, v247
    s_mov_b64 exec, -1
    s_waitcnt lgkmcnt(7)
    v_mfma_f32_32x32x16_bf16 v[160:175], v[196:199], v[180:183], v[160:175]
    v_dot2c_f32_bf16 v217, s66, v192
    v_dot2c_f32_bf16 v218, s66, v193
    v_dot2c_f32_bf16 v217, s66, v194
    v_dot2c_f32_bf16 v218, s66, v195
    ds_read_b128 v[176:179], v212 offset:49152
    ds_read_b64_tr_b16 v[192:193], v216 offset:57344
    ds_read_b64_tr_b16 v[194:195], v216 offset:57856
    v_dot2c_f32_bf16 v217, s66, v196
    v_dot2c_f32_bf16 v218, s66, v197
    v_dot2c_f32_bf16 v217, s66, v198
    v_dot2c_f32_bf16 v218, s66, v199
    v_mov_b32 v246, 163100
    s_mov_b32 s70, 400000
L_st2_9:
    ds_read_b32 v247, v246
    s_sub_u32 s70, s70, 1
    s_cbranch_scc1 L_st2_9_x
    s_waitcnt lgkmcnt(0)
    v_readfirstlane_b32 s63, v247
    s_cmp_ge_u32 s63, 4
    s_cbranch_scc0 L_st2_9
L_st2_9_x:
    s_waitcnt lgkmcnt(0)
    v_and_b32 v3, 31, v0
    v_lshlrev_b32 v3, 4, v3
    s_lshl_b32 s57, s54, 10
    v_add_u32 v3, s57, v3
    v_add_u32 v3, 160768, v3
    ds_read_b128 v[220:223], v3
    ds_read_b128 v[224:227], v3 offset:512
    s_waitcnt lgkmcnt(2)
    v_mfma_f32_32x32x16_bf16 v[160:175], v[200:203], v[184:187], v[160:175]
    ds_read_b128 v[180:183], v213 offset:49152
    ds_read_b64_tr_b16 v[196:197], v216 offset:59392
    ds_read_b64_tr_b16 v[198:199], v216 offset:59904
    s_waitcnt lgkmcnt(5)
    v_mfma_f32_32x32x16_bf16 v[160:175], v[204:207], v[188:191], v[160:175]
    v_dot2c_f32_bf16 v217, s66, v200
    v_dot2c_f32_bf16 v218, s66, v201
    v_dot2c_f32_bf16 v217, s66, v202
    v_dot2c_f32_bf16 v218, s66, v203
    ds_read_b128 v[184:187], v214 offset:49152
    ds_read_b64_tr_b16 v[200:201], v216 offset:61440
    ds_read_b64_tr_b16 v[202:203], v216 offset:61952
    v_dot2c_f32_bf16 v217, s66, v204
    v_dot2c_f32_bf16 v218, s66, v205
    v_dot2c_f32_bf16 v217, s66, v206
    v_dot2c_f32_bf16 v218, s66, v207
    s_waitcnt lgkmcnt(8)
    v_mfma_f32_32x32x16_bf16 v[160:175], v[192:195], v[176:179], v[160:175]
    ds_read_b128 v[188:191], v215 offset:49152
    ds_read_b64_tr_b16 v[204:205], v216 offset:63488
    ds_read_b64_tr_b16 v[206:207], v216 offset:64000
    s_waitcnt lgkmcnt(6)
    v_mfma_f32_32x32x16_bf16 v[160:175], v[196:199], v[180:183], v[160:175]
    v_dot2c_f32_bf16 v217, s66, v192
    v_dot2c_f32_bf16 v218, s66, v193
    v_dot2c_f32_bf16 v217, s66, v194
    v_dot2c_f32_bf16 v218, s66, v195
    v_dot2c_f32_bf16 v217, s66, v196
    v_dot2c_f32_bf16 v218, s66, v197
    v_dot2c_f32_bf16 v217, s66, v198
    v_dot2c_f32_bf16 v218, s66, v199
    v_add_f32 v220, v220, v221
    v_add_f32 v224, v224, v225
    v_add_f32 v222, v222, v223
    v_add_f32 v226, v226, v227
    v_add_f32 v220, v220, v222
    v_add_f32 v224, v224, v226
    v_mul_f32 v237, 0xbb000000, v220
    v_mul_f32 v238, 0x3b000000, v224
    v_fma_f32 v238, -v237, v237, v238
    v_max_f32 v238, 0, v238
    v_add_f32 v238, 0x3727c5ac, v238
    v_rsq_f32 v236, v238
    s_waitcnt lgkmcnt(3)
    v_mfma_f32_32x32x16_bf16 v[160:175], v[200:203], v[184:187], v[160:175]
    v_cvt_pk_bf16_f32 v238, v237, v237
    v_mov_b32 v230, 0
    v_and_b32 v238, 0xffff0000, v238
    v_mov_b32 v231, 0
    v_sub_f32 v238, v237, v238
    v_cvt_pk_bf16_f32 v238, v237, v238
    v_cndmask_b32 v228, v238, 0, s[64:65]
    v_cndmask_b32 v229, v238, 0, s[64:65]
    v_mul_f32 v236, 0x3eb8aa3b, v236
    s_waitcnt lgkmcnt(0)
    v_mfma_f32_32x32x16_bf16 v[160:175], v[204:207], v[188:191], v[160:175]
    v_dot2c_f32_bf16 v217, s66, v200
    v_dot2c_f32_bf16 v218, s66, v201
    v_dot2c_f32_bf16 v217, s66, v202
    v_dot2c_f32_bf16 v218, s66, v203
    v_dot2c_f32_bf16 v217, s66, v204
    v_dot2c_f32_bf16 v218, s66, v205
    v_dot2c_f32_bf16 v217, s66, v206
    v_dot2c_f32_bf16 v218, s66, v207
    s_nop 2
    v_add_f32 v217, v217, v218
    s_nop 0
    v_mov_b32 v218, v217
    s_nop 1
    v_permlane32_swap_b32 v217, v218
    v_add_f32 v217, v217, v218
    v_cvt_pk_bf16_f32 v232, v217, v217
    v_mov_b32 v234, 0
    v_and_b32 v238, 0xffff0000, v232
    v_mov_b32 v235, 0
    v_sub_f32 v238, v217, v238
    v_cvt_pk_bf16_f32 v233, v238, v238
    s_nop 1
    v_mfma_f32_32x32x16_bf16 v[160:175], v[232:235], v[228:231], v[160:175]
    v_add_u32 v3, 152576, v1
    s_lshl_b32 s57, s48, 11
    v_add_u32 v3, s57, v3
    s_nop 7
    s_nop 1
    v_mul_f32 v160, v160, v236
    v_mul_f32 v161, v161, v236
    v_mul_f32 v162, v162, v236
    v_mul_f32 v163, v163, v236
    v_mul_f32 v164, v164, v236
    v_mul_f32 v165, v165, v236
    v_mul_f32 v166, v166, v236
    v_mul_f32 v167, v167, v236
    v_mul_f32 v168, v168, v236
    v_mul_f32 v169, v169, v236
    v_mul_f32 v170, v170, v236
    v_mul_f32 v171, v171, v236
    v_mul_f32 v172, v172, v236
    v_mul_f32 v173, v173, v236
    v_mul_f32 v174, v174, v236
    v_mul_f32 v175, v175, v236
    v_cvt_pk_bf16_f32 v12, v160, v161
    v_cvt_pk_bf16_f32 v13, v162, v163
    v_cvt_pk_bf16_f32 v14, v164, v165
    v_cvt_pk_bf16_f32 v15, v166, v167
    v_cvt_pk_bf16_f32 v16, v168, v169
    v_cvt_pk_bf16_f32 v17, v170, v171
    v_cvt_pk_bf16_f32 v18, v172, v173
    v_cvt_pk_bf16_f32 v19, v174, v175
    ds_write_b128 v3, v[12:15]
    ds_write_b128 v3, v[16:19] offset:1024
    v_and_b32 v158, 15, v0
    v_lshlrev_b32 v158, 4, v158
    v_lshrrev_b32 v159, 5, v0
    v_lshl_add_u32 v158, v159, 8, v158
    v_and_b32 v159, 16, v0
    v_cmp_ne_u32 s[74:75], 0, v159
    v_add_u32 v159, -4, v0
    v_and_b32 v159, 31, v159
    v_cmp_gt_u32 vcc, 24, v159
    v_mov_b32 v157, 147456
    v_mov_b32 v159, 147520
    v_cndmask_b32 v157, v157, v159, vcc
    s_lshl_b32 s57, s56, 16
    s_lshl_b32 s58, s56, 13
    s_add_u32 s58, s58, 131072
    v_add_u32 v151, s58, v1
    v_add_u32 v148, s57, v1
    s_add_u32 s58, s58, 4096
    v_add_u32 v152, s58, v158
    s_add_u32 s57, s57, 28672
    v_add_u32 v153, s57, v158
    v_add_u32 v149, 5120, v153
    v_add_u32 v150, 9216, v153
    v_mov_b32 v154, 8192
    v_cndmask_b32 v152, v152, v157, s[74:75]
    v_cndmask_b32 v153, v153, v157, s[74:75]
    v_cndmask_b32 v149, v149, v157, s[74:75]
    v_cndmask_b32 v150, v150, v157, s[74:75]
    v_cndmask_b32 v154, v154, 0, s[74:75]
    s_waitcnt lgkmcnt(0)
    s_barrier
    s_branch L_attn
.p2align 9
L_g1_a:
    s_lshr_b32 s56, s48, 2
    s_lshr_b32 s54, s48, 1
    s_and_b32 s54, s54, 1
    s_and_b32 s55, s48, 1
    s_and_b32 s76, s48, 3
    s_mov_b32 s64, 0
    s_mov_b32 s65, -1
    s_lshl_b32 s67, s49, 1
    s_waitcnt lgkmcnt(0)
    s_mov_b32 s28, s26
    s_mov_b32 s29, s27
    s_mov_b32 s30, 16777216
    s_mov_b32 s31, 0x20000
    s_mov_b32 s44, s24
    s_mov_b32 s45, s25
    s_mov_b32 s46, 256
    s_mov_b32 s47, 0x20000
    v_lshlrev_b32 v250, 6, v0
    s_mov_b32 s36, s6
    s_mov_b32 s37, s7
    s_mov_b32 s38, 524288
    s_mov_b32 s39, 0x20000
    v_lshrrev_b32 v4, 1, v0
    v_lshlrev_b32 v4, 10, v4
    v_and_b32 v5, 1, v0
    v_lshl_add_u32 v58, v5, 6, v4
    s_and_b32 s57, s52, 3
    s_lshl_b32 s57, s57, 16
    s_and_b32 s58, s76, 1
    s_lshl_b32 s58, s58, 15
    s_add_u32 s57, s57, s58
    s_lshl_b32 s58, s50, 7
    s_add_u32 s81, s57, s58
    s_cmp_ge_u32 s76, 2
    s_cbranch_scc1 L_ta_wq
    s_mov_b32 s32, s4
    s_mov_b32 s33, s5
    s_mov_b32 s34, 2097152
    s_mov_b32 s35, 0x20000
    s_lshl_b32 s57, s49, 16
    s_lshl_b32 s58, s50, 13
    s_add_u32 s57, s57, s58
    s_lshl_b32 s58, s76, 12
    s_add_u32 s57, s57, s58
    buffer_load_dword v251, v250, s[32:35], s57 offen
    s_cmp_ge_u32 s50, 4
    s_cbranch_scc1 L_ta_done
    s_cmp_eq_u32 s76, 0
    s_cbranch_scc0 L_ta_done
    s_cmp_ge_u32 s50, 2
    s_cselect_b32 s40, s10, s8
    s_cselect_b32 s41, s11, s9
    s_mov_b32 s42, 16384
    s_mov_b32 s43, 0x20000
    s_and_b32 s57, s52, 3
    s_lshl_b32 s57, s57, 12
    buffer_load_dword v251, v250, s[40:43], s57 offen
    s_branch L_ta_done
L_ta_wq:
    s_add_u32 s57, s81, 262144
L_ta_done:
    s_cmp_eq_u32 s2, 0
    s_cselect_b32 s57, 1, 0
    s_cmp_eq_u32 s48, 4
    s_cselect_b32 s57, s57, 0
    s_cmp_eq_u32 s57, 1
    s_cbranch_scc0 L_nononce
    s_memrealtime s[58:59]
    s_waitcnt lgkmcnt(0)
    s_or_b32 s58, s58, 1
    v_mov_b32 v4, s58
    v_mov_b32 v5, 0
    s_mov_b64 exec, 1
    buffer_store_dword v4, v5, s[44:47], 0 offen sc1
    s_mov_b64 exec, -1
L_nononce:
    s_add_u32 s67, s67, s54
    s_mov_b32 s66, 0x3f803f80
    v_lshrrev_b32 v3, 2, v0
    v_and_b32 v3, 4, v3
    v_and_b32 v4, 7, v0
    v_xor_b32 v4, v4, v3
    v_lshlrev_b32 v4, 4, v4
    v_lshrrev_b32 v3, 3, v0
    v_lshl_add_u32 v2, v3, 10, v4
    v_mov_b32 v4, s66
    v_mov_b32 v5, s66
    v_mov_b32 v6, s66
    v_mov_b32 v7, s66
    s_lshl_b32 s57, s76, 10
    v_add_u32 v3, s57, v1
    v_add_u32 v3, 147456, v3
    v_add_u32 v8, 151552, v1
    ds_write_b128 v3, v[4:7]
    ds_write_b128 v8, v[4:7]
    v_mov_b32 v9, 163088
    v_mov_b32 v12, 0
    v_mov_b32 v13, 0
    v_mov_b32 v14, 0
    v_mov_b32 v15, 0
    ds_write_b128 v9, v[12:15]
    v_and_b32 v4, 15, v0
    v_lshrrev_b32 v5, 2, v4
    v_lshrrev_b32 v6, 5, v0
    v_lshl_add_u32 v5, v6, 3, v5
    v_lshlrev_b32 v5, 5, v5
    v_and_b32 v4, 3, v4
    v_lshl_add_u32 v5, v4, 3, v5
    s_lshl_b32 s57, s76, 12
    s_add_u32 s57, s57, 131072
    v_add_u32 v244, s57, v5
    v_mov_b32 v242, 0
    v_and_b32 v4, 16, v0
    v_cmp_ne_u32 vcc, 0, v4
    v_mov_b32 v4, 147456
    s_nop 0
    v_cndmask_b32 v244, v244, v4, vcc
    v_mov_b32 v20, 0
    v_mov_b32 v21, 0
    v_mov_b32 v22, 0
    v_mov_b32 v23, 0
    v_mov_b32 v24, 0
    v_mov_b32 v25, 0
    v_mov_b32 v26, 0
    v_mov_b32 v27, 0
    v_mov_b32 v28, 0
    v_mov_b32 v29, 0
    v_mov_b32 v30, 0
    v_mov_b32 v31, 0
    v_mov_b32 v32, 0
    v_mov_b32 v33, 0
    v_mov_b32 v34, 0
    v_mov_b32 v35, 0
    v_mov_b32 v36, 0
    v_mov_b32 v37, 0
    v_mov_b32 v38, 0
    v_mov_b32 v39, 0
    v_mov_b32 v40, 0
    v_mov_b32 v41, 0
    v_mov_b32 v42, 0
    v_mov_b32 v43, 0
    v_mov_b32 v44, 0
    v_mov_b32 v45, 0
    v_mov_b32 v46, 0
    v_mov_b32 v47, 0
    v_mov_b32 v48, 0
    v_mov_b32 v49, 0
    v_mov_b32 v50, 0
    v_mov_b32 v51, 0
    v_mov_b32 v155, 0
    v_mov_b32 v156, 0
    v_mov_b32 v7, 0
    v_add_u32 v55, 152576, v1
    v_and_b32 v5, 31, v0
    v_lshlrev_b32 v52, 5, v5
    v_lshlrev_b32 v5, 4, v5
    s_lshl_b32 s57, s71, 10
    s_add_u32 s57, s57, 160768
    v_add_u32 v56, s57, v5
    v_and_b32 v9, 15, v0
    v_lshlrev_b32 v54, 4, v9
    v_add_u32 v57, 162816, v54
    v_lshrrev_b32 v10, 5, v0
    v_lshl_add_u32 v52, v10, 3, v52
    v_add_u32 v52, 152576, v52
    v_lshrrev_b32 v53, 2, v9
    v_lshl_add_u32 v53, v10, 2, v53
    v_and_b32 v11, 16, v0
    v_add_u32 v53, v53, v11
    v_lshlrev_b32 v53, 5, v53
    v_and_b32 v9, 3, v9
    v_lshl_add_u32 v53, v9, 3, v53
    v_add_u32 v53, 152576, v53
    v_lshl_add_u32 v54, v10, 8, v54
    v_lshl_add_u32 v54, v11, 5, v54
    s_lshl_b32 s57, s49, 1
    s_add_u32 s57, s57, s71
    s_lshl_b32 s79, s57, 10
    s_lshl_b32 s80, s57, 7
    s_cmp_ge_u32 s50, 2
    s_cselect_b32 s61, 65536, 0
    s_cselect_b32 s62, 8192, 0
    s_add_u32 s79, s79, s61
    s_add_u32 s80, s80, s62
    s_add_u32 s80, s80, 212992
    s_waitcnt lgkmcnt(0)
    s_barrier
    s_setprio 2
    s_cmp_ge_u32 s76, 2
    s_cbranch_scc0 L_wqt2
    buffer_load_dword v251, v58, s[36:39], s81 offen
    s_add_u32 s57, s81, 262144
L_wqt2:
    s_cmp_ge_u32 s50, 4
    s_cbranch_scc1 L_g1_nokv
    v_and_b32 v3, 31, v0
    s_lshl_b32 s57, s71, 5
    v_add_u32 v3, s57, v3
    v_lshrrev_b32 v243, 5, v0
    v_xor_b32 v243, v243, v0
    v_and_b32 v243, 15, v243
    v_lshlrev_b32 v243, 4, v243
    v_lshl_add_u32 v243, v3, 8, v243
    s_lshl_b32 s57, s76, 14
    v_add_u32 v243, s57, v243
    v_mov_b32 v240, 0
    v_mov_b32 v241, 0
    v_xor_b32 v245, 0, v243
    ds_read_b128 v[176:179], v245
    ds_read_b64_tr_b16 v[208:209], v244 offset:0
    ds_read_b64_tr_b16 v[210:211], v244 offset:128
    v_xor_b32 v245, 32, v243
    ds_read_b128 v[180:183], v245
    ds_read_b64_tr_b16 v[212:213], v244 offset:512
    ds_read_b64_tr_b16 v[214:215], v244 offset:640
    v_xor_b32 v245, 64, v243
    ds_read_b128 v[184:187], v245
    ds_read_b64_tr_b16 v[216:217], v244 offset:1024
    ds_read_b64_tr_b16 v[218:219], v244 offset:1152
    v_xor_b32 v245, 96, v243
    ds_read_b128 v[188:191], v245
    ds_read_b64_tr_b16 v[220:221], v244 offset:1536
    ds_read_b64_tr_b16 v[222:223], v244 offset:1664
    s_waitcnt lgkmcnt(9)
    v_mfma_f32_32x32x16_bf16 v[160:175], v[208:211], v[176:179], 0
    v_xor_b32 v245, 128, v243
    ds_read_b128 v[192:195], v245
    ds_read_b64_tr_b16 v[224:225], v244 offset:2048
    ds_read_b64_tr_b16 v[226:227], v244 offset:2176
    v_dot2c_f32_bf16 v241, v176, v176
    v_dot2c_f32_bf16 v242, s66, v208
    v_dot2c_f32_bf16 v241, v177, v177
    v_dot2c_f32_bf16 v242, s66, v209
    v_dot2c_f32_bf16 v241, v178, v178
    v_dot2c_f32_bf16 v242, s66, v210
    v_dot2c_f32_bf16 v241, v179, v179
    v_dot2c_f32_bf16 v242, s66, v211
    s_waitcnt lgkmcnt(9)
    v_mfma_f32_32x32x16_bf16 v[160:175], v[212:215], v[180:183], v[160:175]
    v_xor_b32 v245, 160, v243
    ds_read_b128 v[196:199], v245
    ds_read_b64_tr_b16 v[228:229], v244 offset:2560
    ds_read_b64_tr_b16 v[230:231], v244 offset:2688
    v_dot2c_f32_bf16 v241, v180, v180
    v_dot2c_f32_bf16 v242, s66, v212
    v_dot2c_f32_bf16 v241, v181, v181
    v_dot2c_f32_bf16 v242, s66, v213
    v_dot2c_f32_bf16 v241, v182, v182
    v_dot2c_f32_bf16 v242, s66, v214
    v_dot2c_f32_bf16 v241, v183, v183
    v_dot2c_f32_bf16 v242, s66, v215
    s_waitcnt lgkmcnt(9)
    v_mfma_f32_32x32x16_bf16 v[160:175], v[216:219], v[184:187], v[160:175]
    v_xor_b32 v245, 192, v243
    ds_read_b128 v[200:203], v245
    ds_read_b64_tr_b16 v[232:233], v244 offset:3072
    ds_read_b64_tr_b16 v[234:235], v244 offset:3200
    v_dot2c_f32_bf16 v241, v184, v184
    v_dot2c_f32_bf16 v242, s66, v216
    v_dot2c_f32_bf16 v241, v185, v185
    v_dot2c_f32_bf16 v242, s66, v217
    v_dot2c_f32_bf16 v241, v186, v186
    v_dot2c_f32_bf16 v242, s66, v218
    v_dot2c_f32_bf16 v241, v187, v187
    v_dot2c_f32_bf16 v242, s66, v219
    s_waitcnt lgkmcnt(9)
    v_mfma_f32_32x32x16_bf16 v[160:175], v[220:223], v[188:191], v[160:175]
    v_xor_b32 v245, 224, v243
    ds_read_b128 v[204:207], v245
    ds_read_b64_tr_b16 v[236:237], v244 offset:3584
    ds_read_b64_tr_b16 v[238:239], v244 offset:3712
    v_dot2c_f32_bf16 v241, v188, v188
    v_dot2c_f32_bf16 v242, s66, v220
    v_dot2c_f32_bf16 v241, v189, v189
    v_dot2c_f32_bf16 v242, s66, v221
    v_dot2c_f32_bf16 v241, v190, v190
    v_dot2c_f32_bf16 v242, s66, v222
    v_dot2c_f32_bf16 v241, v191, v191
    v_dot2c_f32_bf16 v242, s66, v223
    s_waitcnt lgkmcnt(9)
    v_mfma_f32_32x32x16_bf16 v[160:175], v[224:227], v[192:195], v[160:175]
    v_dot2c_f32_bf16 v241, v192, v192
    v_dot2c_f32_bf16 v242, s66, v224
    v_dot2c_f32_bf16 v241, v193, v193
    v_dot2c_f32_bf16 v242, s66, v225
    v_dot2c_f32_bf16 v241, v194, v194
    v_dot2c_f32_bf16 v242, s66, v226
    v_dot2c_f32_bf16 v241, v195, v195
    v_dot2c_f32_bf16 v242, s66, v227
    s_waitcnt lgkmcnt(6)
    v_mfma_f32_32x32x16_bf16 v[160:175], v[228:231], v[196:199], v[160:175]
    v_dot2c_f32_bf16 v241, v196, v196
    v_dot2c_f32_bf16 v242, s66, v228
    v_dot2c_f32_bf16 v241, v197, v197
    v_dot2c_f32_bf16 v242, s66, v229
    v_dot2c_f32_bf16 v241, v198, v198
    v_dot2c_f32_bf16 v242, s66, v230
    v_dot2c_f32_bf16 v241, v199, v199
    v_dot2c_f32_bf16 v242, s66, v231
    s_waitcnt lgkmcnt(3)
    v_mfma_f32_32x32x16_bf16 v[160:175], v[232:235], v[200:203], v[160:175]
    v_dot2c_f32_bf16 v241, v200, v200
    v_dot2c_f32_bf16 v242, s66, v232
    v_dot2c_f32_bf16 v241, v201, v201
    v_dot2c_f32_bf16 v242, s66, v233
    v_dot2c_f32_bf16 v241, v202, v202
    v_dot2c_f32_bf16 v242, s66, v234
    v_dot2c_f32_bf16 v241, v203, v203
    v_dot2c_f32_bf16 v242, s66, v235
    s_waitcnt lgkmcnt(0)
    v_mfma_f32_32x32x16_bf16 v[160:175], v[236:239], v[204:207], v[160:175]
    v_dot2c_f32_bf16 v241, v204, v204
    v_dot2c_f32_bf16 v242, s66, v236
    v_dot2c_f32_bf16 v241, v205, v205
    v_dot2c_f32_bf16 v242, s66, v237
    v_dot2c_f32_bf16 v241, v206, v206
    v_dot2c_f32_bf16 v242, s66, v238
    v_dot2c_f32_bf16 v241, v207, v207
    v_dot2c_f32_bf16 v242, s66, v239
    s_nop 1
    v_lshlrev_b32 v245, 4, v0
    s_lshl_b32 s57, s71, 10
    s_lshl_b32 s58, s76, 2
    s_add_u32 s57, s57, s58
    s_add_u32 s57, s57, 160768
    v_mov_b32 v240, v241
    v_add_u32 v245, s57, v245
    s_nop 0
    v_permlane32_swap_b32 v240, v241
    v_add_f32 v240, v240, v241
    s_nop 4
    v_cndmask_b32 v240, v168, v240, s[64:65]
    ds_write_b32 v245, v240
    v_mov_b32 v245, v242
    s_lshl_b32 s57, s76, 11
    s_add_u32 s57, s57, 152576
    v_permlane32_swap_b32 v242, v245
    v_add_u32 v4, s57, v1
    v_add_f32 v242, v242, v245
    v_and_b32 v5, 15, v0
    v_lshlrev_b32 v5, 4, v5
    s_lshl_b32 s57, s76, 2
    s_add_u32 s57, s57, 162816
    v_add_u32 v5, s57, v5
    s_mov_b64 exec, 0xffff
    ds_write_b32 v5, v242
    s_mov_b64 exec, -1
    s_nop 4
    ds_write_b128 v4, v[160:163]
    ds_write_b128 v4, v[164:167] offset:1024
    s_branch L_g1_st
L_g1_nokv:
    v_and_b32 v3, 31, v0
    s_lshl_b32 s57, s71, 5
    v_add_u32 v3, s57, v3
    v_lshrrev_b32 v243, 5, v0
    v_xor_b32 v243, v243, v0
    v_and_b32 v243, 15, v243
    v_lshlrev_b32 v243, 4, v243
    v_lshl_add_u32 v243, v3, 8, v243
    s_lshl_b32 s57, s76, 14
    v_add_u32 v243, s57, v243
    v_mov_b32 v240, 0
    v_mov_b32 v241, 0
    v_xor_b32 v245, 0, v243
    ds_read_b128 v[176:179], v245
    v_xor_b32 v245, 32, v243
    ds_read_b128 v[180:183], v245
    v_xor_b32 v245, 64, v243
    ds_read_b128 v[184:187], v245
    v_xor_b32 v245, 96, v243
    ds_read_b128 v[188:191], v245
    v_xor_b32 v245, 128, v243
    ds_read_b128 v[192:195], v245
    v_xor_b32 v245, 160, v243
    ds_read_b128 v[196:199], v245
    v_xor_b32 v245, 192, v243
    ds_read_b128 v[200:203], v245
    v_xor_b32 v245, 224, v243
    ds_read_b128 v[204:207], v245
    s_waitcnt lgkmcnt(7)
    v_dot2c_f32_bf16 v240, s66, v176
    v_dot2c_f32_bf16 v241, v176, v176
    v_dot2c_f32_bf16 v240, s66, v177
    v_dot2c_f32_bf16 v241, v177, v177
    v_dot2c_f32_bf16 v240, s66, v178
    v_dot2c_f32_bf16 v241, v178, v178
    v_dot2c_f32_bf16 v240, s66, v179
    v_dot2c_f32_bf16 v241, v179, v179
    s_waitcnt lgkmcnt(6)
    v_dot2c_f32_bf16 v240, s66, v180
    v_dot2c_f32_bf16 v241, v180, v180
    v_dot2c_f32_bf16 v240, s66, v181
    v_dot2c_f32_bf16 v241, v181, v181
    v_dot2c_f32_bf16 v240, s66, v182
    v_dot2c_f32_bf16 v241, v182, v182
    v_dot2c_f32_bf16 v240, s66, v183
    v_dot2c_f32_bf16 v241, v183, v183
    s_waitcnt lgkmcnt(5)
    v_dot2c_f32_bf16 v240, s66, v184
    v_dot2c_f32_bf16 v241, v184, v184
    v_dot2c_f32_bf16 v240, s66, v185
    v_dot2c_f32_bf16 v241, v185, v185
    v_dot2c_f32_bf16 v240, s66, v186
    v_dot2c_f32_bf16 v241, v186, v186
    v_dot2c_f32_bf16 v240, s66, v187
    v_dot2c_f32_bf16 v241, v187, v187
    s_waitcnt lgkmcnt(4)
    v_dot2c_f32_bf16 v240, s66, v188
    v_dot2c_f32_bf16 v241, v188, v188
    v_dot2c_f32_bf16 v240, s66, v189
    v_dot2c_f32_bf16 v241, v189, v189
    v_dot2c_f32_bf16 v240, s66, v190
    v_dot2c_f32_bf16 v241, v190, v190
    v_dot2c_f32_bf16 v240, s66, v191
    v_dot2c_f32_bf16 v241, v191, v191
    s_waitcnt lgkmcnt(3)
    v_dot2c_f32_bf16 v240, s66, v192
    v_dot2c_f32_bf16 v241, v192, v192
    v_dot2c_f32_bf16 v240, s66, v193
    v_dot2c_f32_bf16 v241, v193, v193
    v_dot2c_f32_bf16 v240, s66, v194
    v_dot2c_f32_bf16 v241, v194, v194
    v_dot2c_f32_bf16 v240, s66, v195
    v_dot2c_f32_bf16 v241, v195, v195
    s_waitcnt lgkmcnt(2)
    v_dot2c_f32_bf16 v240, s66, v196
    v_dot2c_f32_bf16 v241, v196, v196
    v_dot2c_f32_bf16 v240, s66, v197
    v_dot2c_f32_bf16 v241, v197, v197
    v_dot2c_f32_bf16 v240, s66, v198
    v_dot2c_f32_bf16 v241, v198, v198
    v_dot2c_f32_bf16 v240, s66, v199
    v_dot2c_f32_bf16 v241, v199, v199
    s_waitcnt lgkmcnt(1)
    v_dot2c_f32_bf16 v240, s66, v200
    v_dot2c_f32_bf16 v241, v200, v200
    v_dot2c_f32_bf16 v240, s66, v201
    v_dot2c_f32_bf16 v241, v201, v201
    v_dot2c_f32_bf16 v240, s66, v202
    v_dot2c_f32_bf16 v241, v202, v202
    v_dot2c_f32_bf16 v240, s66, v203
    v_dot2c_f32_bf16 v241, v203, v203
    s_waitcnt lgkmcnt(0)
    v_dot2c_f32_bf16 v240, s66, v204
    v_dot2c_f32_bf16 v241, v204, v204
    v_dot2c_f32_bf16 v240, s66, v205
    v_dot2c_f32_bf16 v241, v205, v205
    v_dot2c_f32_bf16 v240, s66, v206
    v_dot2c_f32_bf16 v241, v206, v206
    v_dot2c_f32_bf16 v240, s66, v207
    v_dot2c_f32_bf16 v241, v207, v207
    s_nop 1
    v_lshlrev_b32 v245, 4, v0
    s_lshl_b32 s57, s71, 10
    s_lshl_b32 s58, s76, 2
    s_add_u32 s57, s57, s58
    s_add_u32 s57, s57, 160768
    v_permlane32_swap_b32 v240, v241
    v_add_u32 v245, s57, v245
    v_add_f32 v240, v240, v241
    ds_write_b32 v245, v240
L_g1_st:
    s_waitcnt lgkmcnt(0)
    v_mov_b32 v246, 163096
    v_mov_b32 v247, 1
    s_mov_b64 exec, 1
    ds_add_u32 v246, v247
    s_mov_b64 exec, -1
    s_mov_b32 s59, 0
    s_cmp_ge_u32 s50, 4
    s_cbranch_scc1 L_g1_b3
    s_cmp_eq_u32 s48, 4
    s_cbranch_scc0 L_g1_b3
    v_mov_b32 v246, 163096
    s_mov_b32 s70, 400000
L_kvp_10:
    ds_read_b32 v247, v246
    s_sub_u32 s70, s70, 1
    s_cbranch_scc1 L_kvp_10_x
    s_waitcnt lgkmcnt(0)
    v_readfirstlane_b32 s63, v247
    s_cmp_ge_u32 s63, 4
    s_cbranch_scc0 L_kvp_10
L_kvp_10_x:
    s_waitcnt lgkmcnt(0)
    ds_read_b128 v[208:211], v56
    ds_read_b128 v[212:215], v56 offset:512
    ds_read_b128 v[216:219], v57
    ds_read_b128 v[176:179], v55 offset:0
    ds_read_b128 v[180:183], v55 offset:1024
    ds_read_b128 v[184:187], v55 offset:2048
    ds_read_b128 v[188:191], v55 offset:3072
    ds_read_b128 v[192:195], v55 offset:4096
    ds_read_b128 v[196:199], v55 offset:5120
    ds_read_b128 v[200:203], v55 offset:6144
    ds_read_b128 v[204:207], v55 offset:7168
    buffer_load_dword v8, v7, s[44:47], 0 offen sc1
    s_waitcnt lgkmcnt(9)
    v_add_f32 v208, v208, v209
    v_add_f32 v212, v212, v213
    v_add_f32 v210, v210, v211
    v_add_f32 v214, v214, v215
    v_add_f32 v208, v208, v210
    v_add_f32 v212, v212, v214
    v_mul_f32 v228, 0xbb000000, v208
    v_mul_f32 v230, 0x3b000000, v212
    v_fma_f32 v230, -v228, v228, v230
    v_max_f32 v230, 0, v230
    v_add_f32 v230, 0x3727c5ac, v230
    v_rsq_f32 v229, v230
    v_cvt_pk_bf16_f32 v230, v228, v228
    v_mov_b32 v222, 0
    v_and_b32 v230, 0xffff0000, v230
    v_mov_b32 v223, 0
    v_sub_f32 v230, v228, v230
    v_cvt_pk_bf16_f32 v230, v228, v230
    v_cndmask_b32 v220, v230, 0, s[64:65]
    v_cndmask_b32 v221, v230, 0, s[64:65]
    s_waitcnt lgkmcnt(8)
    v_add_f32 v216, v216, v217
    v_add_f32 v218, v218, v219
    v_add_f32 v216, v216, v218
    v_cvt_pk_bf16_f32 v224, v216, v216
    v_mov_b32 v226, 0
    v_and_b32 v230, 0xffff0000, v224
    v_mov_b32 v227, 0
    v_sub_f32 v230, v216, v230
    v_cvt_pk_bf16_f32 v225, v230, v230
    s_waitcnt lgkmcnt(4)
    v_add_f32 v176, v176, v184
    v_add_f32 v177, v177, v185
    v_add_f32 v178, v178, v186
    v_add_f32 v179, v179, v187
    v_add_f32 v180, v180, v188
    v_add_f32 v181, v181, v189
    v_add_f32 v182, v182, v190
    v_add_f32 v183, v183, v191
    s_waitcnt lgkmcnt(0)
    v_add_f32 v192, v192, v200
    v_add_f32 v193, v193, v201
    v_add_f32 v194, v194, v202
    v_add_f32 v195, v195, v203
    v_add_f32 v196, v196, v204
    v_add_f32 v197, v197, v205
    v_add_f32 v198, v198, v206
    v_add_f32 v199, v199, v207
    v_add_f32 v160, v176, v192
    v_add_f32 v161, v177, v193
    v_add_f32 v162, v178, v194
    v_add_f32 v163, v179, v195
    v_add_f32 v164, v180, v196
    v_add_f32 v165, v181, v197
    v_add_f32 v166, v182, v198
    v_add_f32 v167, v183, v199
    s_nop 1
    v_mfma_f32_32x32x16_bf16 v[160:175], v[224:227], v[220:223], v[160:175]
    s_cmp_ge_u32 s50, 2
    s_nop 7
    s_nop 2
    v_mul_f32 v160, v160, v229
    v_mul_f32 v161, v161, v229
    v_mul_f32 v162, v162, v229
    v_mul_f32 v163, v163, v229
    v_mul_f32 v164, v164, v229
    v_mul_f32 v165, v165, v229
    v_mul_f32 v166, v166, v229
    v_mul_f32 v167, v167, v229
    v_cvt_pk_bf16_f32 v232, v160, v161
    v_cvt_pk_bf16_f32 v233, v162, v163
    v_cvt_pk_bf16_f32 v234, v164, v165
    v_cvt_pk_bf16_f32 v235, v166, v167
    s_cbranch_scc1 L_g1_v
    buffer_store_dwordx4 v[232:235], v1, s[28:31], s79 offen sc1
    v_mov_b32 v236, 0
    v_dot2c_f32_bf16 v236, v232, v232
    v_dot2c_f32_bf16 v236, v233, v233
    v_dot2c_f32_bf16 v236, v234, v234
    v_dot2c_f32_bf16 v236, v235, v235
    s_nop 2
    v_mov_b32 v237, v236
    s_nop 1
    v_permlane32_swap_b32 v236, v237
    v_add_f32 v236, v236, v237
    s_nop 1
    v_max_f32_dpp v236, v236, v236 row_shr:1 row_mask:0xf bank_mask:0xf
    s_nop 1
    v_max_f32_dpp v236, v236, v236 row_shr:2 row_mask:0xf bank_mask:0xf
    s_nop 1
    v_max_f32_dpp v236, v236, v236 row_shr:4 row_mask:0xf bank_mask:0xf
    s_nop 1
    v_max_f32_dpp v236, v236, v236 row_shr:8 row_mask:0xf bank_mask:0xf
    s_nop 1
    v_max_f32_dpp v236, v236, v236 row_bcast:15 row_mask:0xa bank_mask:0xf
    s_nop 0
    v_readlane_b32 s59, v236, 31
    s_branch L_g1_kvst
L_g1_v:
    ds_write_b64 v52, v[232:233]
    ds_write_b64 v52, v[234:235] offset:16
    s_waitcnt lgkmcnt(0)
    ds_read_b64_tr_b16 v[232:233], v53
    ds_read_b64_tr_b16 v[234:235], v53 offset:256
    s_waitcnt lgkmcnt(0)
    buffer_store_dwordx4 v[232:235], v54, s[28:31], s79 offen sc1
L_g1_kvst:
    s_mov_b32 s70, 400000
    s_waitcnt vmcnt(0)
L_nonce4:
    v_readfirstlane_b32 s53, v8
    s_cmp_lg_u32 s53, 0
    s_cbranch_scc1 L_nonce4_x
    s_sub_u32 s70, s70, 1
    s_cbranch_scc1 L_nonce4_x
    buffer_load_dword v8, v7, s[44:47], 0 offen sc1
    s_waitcnt vmcnt(0)
    s_branch L_nonce4
L_nonce4_x:
    v_mov_b32 v10, s53
    v_mov_b32 v11, s59
    v_mov_b32 v9, s80
    s_mov_b64 exec, 1
    buffer_store_dwordx2 v[10:11], v9, s[28:31], 0 offen sc1
    s_mov_b64 exec, -1
L_g1_b3:
    s_setprio 0
    s_min_u32 s78, s76, 2
    s_add_u32 s78, s78, 1
    s_lshl_b32 s78, s78, 2
    v_mov_b32 v246, 163092
    s_mov_b32 s70, 400000
L_xb_11:
    ds_read_b32 v247, v246
    s_sub_u32 s70, s70, 1
    s_cbranch_scc1 L_xb_11_x
    s_waitcnt lgkmcnt(0)
    v_readfirstlane_b32 s63, v247
    s_cmp_ge_u32 s63, s78
    s_cbranch_scc0 L_xb_11
L_xb_11_x:
    s_waitcnt lgkmcnt(0)
    s_xor_b32 s63, s71, 1
    s_mov_b32 s72, s63
    v_and_b32 v3, 31, v0
    s_lshl_b32 s57, s72, 5
    v_add_u32 v3, s57, v3
    v_lshrrev_b32 v243, 5, v0
    v_xor_b32 v243, v243, v0
    v_and_b32 v243, 15, v243
    v_lshlrev_b32 v243, 4, v243
    v_lshl_add_u32 v243, v3, 8, v243
    s_lshl_b32 s57, s76, 14
    v_add_u32 v243, s57, v243
    v_mov_b32 v240, 0
    v_mov_b32 v241, 0
    v_xor_b32 v245, 0, v243
    ds_read_b128 v[176:179], v245
    v_xor_b32 v245, 32, v243
    ds_read_b128 v[180:183], v245
    v_xor_b32 v245, 64, v243
    ds_read_b128 v[184:187], v245
    v_xor_b32 v245, 96, v243
    ds_read_b128 v[188:191], v245
    v_xor_b32 v245, 128, v243
    ds_read_b128 v[192:195], v245
    v_xor_b32 v245, 160, v243
    ds_read_b128 v[196:199], v245
    v_xor_b32 v245, 192, v243
    ds_read_b128 v[200:203], v245
    v_xor_b32 v245, 224, v243
    ds_read_b128 v[204:207], v245
    s_waitcnt lgkmcnt(7)
    v_dot2c_f32_bf16 v240, s66, v176
    v_dot2c_f32_bf16 v241, v176, v176
    v_dot2c_f32_bf16 v240, s66, v177
    v_dot2c_f32_bf16 v241, v177, v177
    v_dot2c_f32_bf16 v240, s66, v178
    v_dot2c_f32_bf16 v241, v178, v178
    v_dot2c_f32_bf16 v240, s66, v179
    v_dot2c_f32_bf16 v241, v179, v179
    s_waitcnt lgkmcnt(6)
    v_dot2c_f32_bf16 v240, s66, v180
    v_dot2c_f32_bf16 v241, v180, v180
    v_dot2c_f32_bf16 v240, s66, v181
    v_dot2c_f32_bf16 v241, v181, v181
    v_dot2c_f32_bf16 v240, s66, v182
    v_dot2c_f32_bf16 v241, v182, v182
    v_dot2c_f32_bf16 v240, s66, v183
    v_dot2c_f32_bf16 v241, v183, v183
    s_waitcnt lgkmcnt(5)
    v_dot2c_f32_bf16 v240, s66, v184
    v_dot2c_f32_bf16 v241, v184, v184
    v_dot2c_f32_bf16 v240, s66, v185
    v_dot2c_f32_bf16 v241, v185, v185
    v_dot2c_f32_bf16 v240, s66, v186
    v_dot2c_f32_bf16 v241, v186, v186
    v_dot2c_f32_bf16 v240, s66, v187
    v_dot2c_f32_bf16 v241, v187, v187
    s_waitcnt lgkmcnt(4)
    v_dot2c_f32_bf16 v240, s66, v188
    v_dot2c_f32_bf16 v241, v188, v188
    v_dot2c_f32_bf16 v240, s66, v189
    v_dot2c_f32_bf16 v241, v189, v189
    v_dot2c_f32_bf16 v240, s66, v190
    v_dot2c_f32_bf16 v241, v190, v190
    v_dot2c_f32_bf16 v240, s66, v191
    v_dot2c_f32_bf16 v241, v191, v191
    s_waitcnt lgkmcnt(3)
    v_dot2c_f32_bf16 v240, s66, v192
    v_dot2c_f32_bf16 v241, v192, v192
    v_dot2c_f32_bf16 v240, s66, v193
    v_dot2c_f32_bf16 v241, v193, v193
    v_dot2c_f32_bf16 v240, s66, v194
    v_dot2c_f32_bf16 v241, v194, v194
    v_dot2c_f32_bf16 v240, s66, v195
    v_dot2c_f32_bf16 v241, v195, v195
    s_waitcnt lgkmcnt(2)
    v_dot2c_f32_bf16 v240, s66, v196
    v_dot2c_f32_bf16 v241, v196, v196
    v_dot2c_f32_bf16 v240, s66, v197
    v_dot2c_f32_bf16 v241, v197, v197
    v_dot2c_f32_bf16 v240, s66, v198
    v_dot2c_f32_bf16 v241, v198, v198
    v_dot2c_f32_bf16 v240, s66, v199
    v_dot2c_f32_bf16 v241, v199, v199
    s_waitcnt lgkmcnt(1)
    v_dot2c_f32_bf16 v240, s66, v200
    v_dot2c_f32_bf16 v241, v200, v200
    v_dot2c_f32_bf16 v240, s66, v201
    v_dot2c_f32_bf16 v241, v201, v201
    v_dot2c_f32_bf16 v240, s66, v202
    v_dot2c_f32_bf16 v241, v202, v202
    v_dot2c_f32_bf16 v240, s66, v203
    v_dot2c_f32_bf16 v241, v203, v203
    s_waitcnt lgkmcnt(0)
    v_dot2c_f32_bf16 v240, s66, v204
    v_dot2c_f32_bf16 v241, v204, v204
    v_dot2c_f32_bf16 v240, s66, v205
    v_dot2c_f32_bf16 v241, v205, v205
    v_dot2c_f32_bf16 v240, s66, v206
    v_dot2c_f32_bf16 v241, v206, v206
    v_dot2c_f32_bf16 v240, s66, v207
    v_dot2c_f32_bf16 v241, v207, v207
    s_nop 1
    v_lshlrev_b32 v245, 4, v0
    s_lshl_b32 s57, s72, 10
    s_lshl_b32 s58, s76, 2
    s_add_u32 s57, s57, s58
    s_add_u32 s57, s57, 160768
    v_permlane32_swap_b32 v240, v241
    v_add_u32 v245, s57, v245
    v_add_f32 v240, v240, v241
    ds_write_b32 v245, v240
    s_waitcnt lgkmcnt(0)
    v_mov_b32 v246, 163100
    v_mov_b32 v247, 1
    s_mov_b64 exec, 1
    ds_add_u32 v246, v247
    s_mov_b64 exec, -1
    v_and_b32 v158, 15, v0
    v_lshlrev_b32 v158, 4, v158
    v_lshrrev_b32 v159, 5, v0
    v_lshl_add_u32 v158, v159, 8, v158
    v_and_b32 v159, 16, v0
    v_cmp_ne_u32 s[74:75], 0, v159
    v_add_u32 v159, -4, v0
    v_and_b32 v159, 31, v159
    v_cmp_gt_u32 vcc, 24, v159
    v_mov_b32 v157, 147456
    v_mov_b32 v159, 147520
    v_cndmask_b32 v157, v157, v159, vcc
    s_lshl_b32 s57, s56, 16
    s_lshl_b32 s58, s56, 13
    s_add_u32 s58, s58, 131072
    v_add_u32 v151, s58, v1
    v_add_u32 v148, s57, v1
    s_add_u32 s58, s58, 4096
    v_add_u32 v152, s58, v158
    s_add_u32 s57, s57, 28672
    v_add_u32 v153, s57, v158
    v_add_u32 v149, 5120, v153
    v_add_u32 v150, 9216, v153
    v_mov_b32 v154, 8192
    v_cndmask_b32 v152, v152, v157, s[74:75]
    v_cndmask_b32 v153, v153, v157, s[74:75]
    v_cndmask_b32 v149, v149, v157, s[74:75]
    v_cndmask_b32 v150, v150, v157, s[74:75]
    v_cndmask_b32 v154, v154, 0, s[74:75]
    s_cmp_eq_u32 s48, 5
    s_cbranch_scc0 L_g1_b7
    v_mov_b32 v246, 163092
    s_mov_b32 s70, 400000
L_pgate_12:
    ds_read_b32 v247, v246
    s_sub_u32 s70, s70, 1
    s_cbranch_scc1 L_pgate_12_x
    s_waitcnt lgkmcnt(0)
    v_readfirstlane_b32 s63, v247
    s_cmp_ge_u32 s63, 20
    s_cbranch_scc0 L_pgate_12
L_pgate_12_x:
    s_waitcnt lgkmcnt(0)
    s_mov_b32 s70, 400000
    v_lshlrev_b32 v4, 7, v0
    v_add_u32 v4, 212992, v4
    v_add_u32 v5, 8192, v4
    v_mov_b32 v7, 0
L_kvpoll:
    buffer_load_dword v8, v7, s[44:47], 0 offen sc1
    buffer_load_dwordx2 v[10:11], v4, s[28:31], 0 offen sc1
    buffer_load_dword v9, v5, s[28:31], 0 offen sc1
    s_sub_u32 s70, s70, 1
    s_cbranch_scc1 L_kvpoll_x
    s_waitcnt vmcnt(0)
    v_cmp_ne_u32 vcc, v8, v10
    v_cmp_ne_u32 s[74:75], v8, v9
    s_or_b64 vcc, vcc, s[74:75]
    v_cmp_eq_u32 s[74:75], 0, v8
    s_or_b64 vcc, vcc, s[74:75]
    s_cbranch_vccnz L_kvpoll
L_kvpoll_x:
    s_waitcnt vmcnt(0)
    s_nop 1
    v_max_f32_dpp v11, v11, v11 row_shr:1 row_mask:0xf bank_mask:0xf
    s_nop 1
    v_max_f32_dpp v11, v11, v11 row_shr:2 row_mask:0xf bank_mask:0xf
    s_nop 1
    v_max_f32_dpp v11, v11, v11 row_shr:4 row_mask:0xf bank_mask:0xf
    s_nop 1
    v_max_f32_dpp v11, v11, v11 row_shr:8 row_mask:0xf bank_mask:0xf
    s_nop 1
    v_max_f32_dpp v11, v11, v11 row_bcast:15 row_mask:0xa bank_mask:0xf
    s_nop 0
    v_readlane_b32 s57, v11, 31
    v_readlane_b32 s58, v11, 63
    v_mov_b32 v4, 163072
    s_nop 0
    v_mov_b32 v9, s57
    v_mov_b32 v10, s58
    ds_write_b96 v4, v[8:10]
L_g1_b7:
    s_waitcnt lgkmcnt(0)
    s_barrier
    s_lshl_b32 s57, s76, 11
    s_add_u32 s57, s57, 152576
    v_add_u32 v3, s57, v1
    ds_read_b128 v[12:15], v3
    ds_read_b128 v[16:19], v3 offset:1024
L_attn:
    v_mov_b32 v157, 163072
    ds_read_b96 v[84:86], v157
    s_lshr_b32 s57, s76, 1
    s_and_b32 s58, s76, 1
    s_lshl_b32 s59, s56, 13
    s_lshl_b32 s60, s57, 12
    s_add_u32 s59, s59, s60
    s_lshl_b32 s60, s58, 11
    s_add_u32 s59, s59, s60
    s_add_u32 m0, s59, 131072
    s_lshl_b32 s57, s57, 16
    s_lshl_b32 s59, s56, 15
    s_add_u32 s57, s57, s59
    s_add_u32 s57, s57, s60
    s_add_u32 s57, s57, 0
    buffer_load_dwordx4 v1, s[28:31], s57 offen sc1 lds
    s_add_u32 m0, m0, 1024
    s_add_u32 s57, s57, 1024
    buffer_load_dwordx4 v1, s[28:31], s57 offen sc1 lds
    s_and_b32 s57, s76, 1
    s_lshr_b32 s58, s76, 1
    s_mul_i32 s59, s57, 28672
    s_lshl_b32 s60, s56, 16
    s_add_u32 s59, s59, s60
    s_lshl_b32 s60, s58, 10
    s_add_u32 s59, s59, s60
    s_lshl_b32 s57, s57, 16
    s_lshl_b32 s61, s56, 15
    s_add_u32 s57, s57, s61
    s_add_u32 s57, s57, s60
    s_add_u32 s72, s57, 4096
    s_mov_b32 m0, s59
    s_nop 0
    buffer_load_dwordx4 v1, s[28:31], s72 offen sc1 lds
    s_add_u32 m0, m0, 2048
    s_add_u32 s72, s72, 2048
    buffer_load_dwordx4 v1, s[28:31], s72 offen sc1 lds
    s_waitcnt lgkmcnt(0)
    v_readfirstlane_b32 s53, v84
    v_readfirstlane_b32 s59, v85
    v_readfirstlane_b32 s60, v86
    s_cmp_eq_u32 s56, 0
    s_cselect_b32 s69, s59, s60
    s_getreg_b32 s83, hwreg(HW_REG_XCC_ID)
    s_mov_b32 s82, 0
    s_cmp_eq_u32 s48, 6
    s_cbranch_scc0 L_noxt
    s_lshl_b32 s57, s51, 8
    s_lshl_b32 s58, s52, 3
    s_add_u32 s57, s57, s58
    s_add_u32 s57, s57, 204800
    v_mov_b32 v100, s53
    v_mov_b32 v101, s83
    v_mov_b32 v102, 0
    s_mov_b64 exec, 1
    buffer_store_dwordx2 v[100:101], v102, s[28:31], s57 offen sc1
    s_mov_b64 exec, -1
L_noxt:
    v_mov_b32 v157, 0
    v_mov_b32 v158, 0
    v_dot2c_f32_bf16 v157, v12, v12
    v_dot2c_f32_bf16 v158, v16, v16
    v_dot2c_f32_bf16 v157, v13, v13
    v_dot2c_f32_bf16 v158, v17, v17
    v_dot2c_f32_bf16 v157, v14, v14
    v_dot2c_f32_bf16 v158, v18, v18
    v_dot2c_f32_bf16 v157, v15, v15
    v_dot2c_f32_bf16 v158, v19, v19
    s_nop 2
    v_permlane32_swap_b32 v157, v158
    v_add_f32 v157, v157, v158
    v_mul_f32 v157, s69, v157
    v_mov_b32 v159, 0x45610000
    s_nop 0
    v_cmp_le_f32 vcc, v157, v159
    s_nop 1
    s_cmp_eq_u64 vcc, -1
    s_cbranch_scc1 L_fast
    s_lshl_b32 s61, s56, 15
    s_add_u32 s61, s61, 0
    s_mov_b32 s68, 32
    v_mov_b32 v155, 0xff800000
    v_mov_b32 v156, 0xff800000
L_slow:
    buffer_load_dwordx4 v[116:119], v1, s[28:31], s61 offen sc1
    s_add_u32 s61, s61, 1024
    s_waitcnt vmcnt(0)
    v_mfma_f32_32x32x16_bf16 v[84:99], v[116:119], v[12:15], 0
    v_mfma_f32_32x32x16_bf16 v[100:115], v[116:119], v[16:19], 0
    s_nop 7
    s_nop 3
    v_max3_f32 v155, v155, v84, v85
    v_max3_f32 v155, v155, v86, v87
    v_max3_f32 v155, v155, v88, v89
    v_max3_f32 v155, v155, v90, v91
    v_max3_f32 v155, v155, v92, v93
    v_max3_f32 v155, v155, v94, v95
    v_max3_f32 v155, v155, v96, v97
    v_max3_f32 v155, v155, v98, v99
    v_max3_f32 v156, v156, v100, v101
    v_max3_f32 v156, v156, v102, v103
    v_max3_f32 v156, v156, v104, v105
    v_max3_f32 v156, v156, v106, v107
    v_max3_f32 v156, v156, v108, v109
    v_max3_f32 v156, v156, v110, v111
    v_max3_f32 v156, v156, v112, v113
    v_max3_f32 v156, v156, v114, v115
    s_sub_u32 s68, s68, 1
    s_cmp_lg_u32 s68, 0
    s_cbranch_scc1 L_slow
    v_mov_b32 v157, v155
    v_mov_b32 v158, v156
    s_nop 1
    v_permlane32_swap_b32 v155, v157
    v_permlane32_swap_b32 v156, v158
    v_max_f32 v155, v155, v157
    v_max_f32 v156, v156, v158
    v_sub_f32 v20, 0, v155
    v_sub_f32 v36, 0, v156
    v_sub_f32 v21, 0, v155
    v_sub_f32 v37, 0, v156
    v_sub_f32 v22, 0, v155
    v_sub_f32 v38, 0, v156
    v_sub_f32 v23, 0, v155
    v_sub_f32 v39, 0, v156
    v_sub_f32 v24, 0, v155
    v_sub_f32 v40, 0, v156
    v_sub_f32 v25, 0, v155
    v_sub_f32 v41, 0, v156
    v_sub_f32 v26, 0, v155
    v_sub_f32 v42, 0, v156
    v_sub_f32 v27, 0, v155
    v_sub_f32 v43, 0, v156
    v_sub_f32 v28, 0, v155
    v_sub_f32 v44, 0, v156
    v_sub_f32 v29, 0, v155
    v_sub_f32 v45, 0, v156
    v_sub_f32 v30, 0, v155
    v_sub_f32 v46, 0, v156
    v_sub_f32 v31, 0, v155
    v_sub_f32 v47, 0, v156
    v_sub_f32 v32, 0, v155
    v_sub_f32 v48, 0, v156
    v_sub_f32 v33, 0, v155
    v_sub_f32 v49, 0, v156
    v_sub_f32 v34, 0, v155
    v_sub_f32 v50, 0, v156
    v_sub_f32 v35, 0, v155
    v_sub_f32 v51, 0, v156
    s_nop 1
L_fast:
    s_waitcnt vmcnt(2)
    s_barrier
    ds_read_b128 v[124:127], v151
    ds_read_b128 v[128:131], v151 offset:1024
    ds_read_b128 v[132:135], v152
    ds_read_b128 v[140:143], v152 offset:512
    s_waitcnt lgkmcnt(3)
    v_mfma_f32_32x32x16_bf16 v[84:99], v[124:127], v[12:15], v[20:35]
    s_cmp_eq_u32 s56, 0
    s_cbranch_scc0 L_noprio
    s_setprio 1
L_noprio:
    s_nop 7
    s_nop 1
    v_exp_f32 v84, v84
    v_exp_f32 v85, v85
    v_exp_f32 v86, v86
    s_add_u32 m0, m0, 2048
    s_add_u32 s72, s72, 2048
    buffer_load_dwordx4 v1, s[28:31], s72 offen sc1 lds
    v_cvt_pk_bf16_f32 v116, v84, v85
    v_exp_f32 v87, v87
    v_exp_f32 v88, v88
    v_cvt_pk_bf16_f32 v117, v86, v87
    v_exp_f32 v89, v89
    v_exp_f32 v90, v90
    v_cvt_pk_bf16_f32 v118, v88, v89
    v_mfma_f32_32x32x16_bf16 v[100:115], v[124:127], v[16:19], v[36:51]
    v_exp_f32 v91, v91
    v_exp_f32 v92, v92
    v_cvt_pk_bf16_f32 v119, v90, v91
    v_exp_f32 v93, v93
    v_exp_f32 v94, v94
    s_waitcnt lgkmcnt(0)
    v_mfma_f32_32x32x16_bf16 v[52:67], v[132:135], v[116:119], 0
    s_add_u32 m0, m0, 2048
    s_add_u32 s72, s72, 2048
    buffer_load_dwordx4 v1, s[28:31], s72 offen sc1 lds
    v_cvt_pk_bf16_f32 v120, v92, v93
    v_exp_f32 v95, v95
    v_exp_f32 v96, v96
    v_cvt_pk_bf16_f32 v121, v94, v95
    v_exp_f32 v97, v97
    v_exp_f32 v98, v98
    v_cvt_pk_bf16_f32 v122, v96, v97
    v_exp_f32 v99, v99
    v_exp_f32 v100, v100
    v_cvt_pk_bf16_f32 v123, v98, v99
    v_exp_f32 v101, v101
    v_exp_f32 v102, v102
    v_mfma_f32_32x32x16_bf16 v[52:67], v[140:143], v[120:123], v[52:67]
    ds_read_b128 v[124:127], v151 offset:2048
    ds_read_b128 v[136:139], v152 offset:1024
    ds_read_b128 v[144:147], v152 offset:1536
    v_cvt_pk_bf16_f32 v116, v100, v101
    v_exp_f32 v103, v103
    v_exp_f32 v104, v104
    v_cvt_pk_bf16_f32 v117, v102, v103
    v_exp_f32 v105, v105
    v_exp_f32 v106, v106
    v_cvt_pk_bf16_f32 v118, v104, v105
    v_mfma_f32_32x32x16_bf16 v[84:99], v[128:131], v[12:15], v[20:35]
    v_exp_f32 v107, v107
    v_exp_f32 v108, v108
    v_cvt_pk_bf16_f32 v119, v106, v107
    v_exp_f32 v109, v109
    v_exp_f32 v110, v110
    v_mfma_f32_32x32x16_bf16 v[68:83], v[132:135], v[116:119], 0
    s_add_u32 m0, m0, 2048
    s_add_u32 s72, s72, 2048
    buffer_load_dwordx4 v1, s[28:31], s72 offen sc1 lds
    v_cvt_pk_bf16_f32 v120, v108, v109
    v_exp_f32 v111, v111
    v_exp_f32 v112, v112
    v_cvt_pk_bf16_f32 v121, v110, v111
    v_exp_f32 v113, v113
    v_exp_f32 v114, v114
    v_cvt_pk_bf16_f32 v122, v112, v113
    v_exp_f32 v115, v115
    v_exp_f32 v84, v84
    v_cvt_pk_bf16_f32 v123, v114, v115
    v_exp_f32 v85, v85
    v_exp_f32 v86, v86
    v_mfma_f32_32x32x16_bf16 v[68:83], v[140:143], v[120:123], v[68:83]
    s_add_u32 m0, m0, 2048
    s_add_u32 s72, s72, 2048
    buffer_load_dwordx4 v1, s[28:31], s72 offen sc1 lds
    v_cvt_pk_bf16_f32 v116, v84, v85
    v_exp_f32 v87, v87
    v_exp_f32 v88, v88
    v_cvt_pk_bf16_f32 v117, v86, v87
    v_exp_f32 v89, v89
    v_exp_f32 v90, v90
    v_cvt_pk_bf16_f32 v118, v88, v89
    v_mfma_f32_32x32x16_bf16 v[100:115], v[128:131], v[16:19], v[36:51]
    v_exp_f32 v91, v91
    v_exp_f32 v92, v92
    v_cvt_pk_bf16_f32 v119, v90, v91
    v_exp_f32 v93, v93
    v_exp_f32 v94, v94
    s_waitcnt lgkmcnt(0)
    v_mfma_f32_32x32x16_bf16 v[52:67], v[136:139], v[116:119], v[52:67]
    s_add_u32 m0, m0, 2048
    s_add_u32 s72, s72, 2048
    buffer_load_dwordx4 v1, s[28:31], s72 offen sc1 lds
    v_cvt_pk_bf16_f32 v120, v92, v93
    v_exp_f32 v95, v95
    v_exp_f32 v96, v96
    v_cvt_pk_bf16_f32 v121, v94, v95
    v_exp_f32 v97, v97
    v_exp_f32 v98, v98
    v_cvt_pk_bf16_f32 v122, v96, v97
    v_exp_f32 v99, v99
    v_exp_f32 v100, v100
    v_cvt_pk_bf16_f32 v123, v98, v99
    v_exp_f32 v101, v101
    v_exp_f32 v102, v102
    v_mfma_f32_32x32x16_bf16 v[52:67], v[144:147], v[120:123], v[52:67]
    ds_read_b128 v[128:131], v151 offset:3072
    ds_read_b128 v[132:135], v152 offset:2048
    ds_read_b128 v[140:143], v152 offset:2560
    v_cvt_pk_bf16_f32 v116, v100, v101
    v_exp_f32 v103, v103
    v_exp_f32 v104, v104
    v_cvt_pk_bf16_f32 v117, v102, v103
    v_exp_f32 v105, v105
    v_exp_f32 v106, v106
    v_cvt_pk_bf16_f32 v118, v104, v105
    v_mfma_f32_32x32x16_bf16 v[84:99], v[124:127], v[12:15], v[20:35]
    v_exp_f32 v107, v107
    v_exp_f32 v108, v108
    v_cvt_pk_bf16_f32 v119, v106, v107
    v_exp_f32 v109, v109
    v_exp_f32 v110, v110
    v_mfma_f32_32x32x16_bf16 v[68:83], v[136:139], v[116:119], v[68:83]
    s_add_u32 m0, m0, 2048
    s_add_u32 s72, s72, 2048
    buffer_load_dwordx4 v1, s[28:31], s72 offen sc1 lds
    v_cvt_pk_bf16_f32 v120, v108, v109
    v_exp_f32 v111, v111
    v_exp_f32 v112, v112
    v_cvt_pk_bf16_f32 v121, v110, v111
    v_exp_f32 v113, v113
    v_exp_f32 v114, v114
    v_cvt_pk_bf16_f32 v122, v112, v113
    v_exp_f32 v115, v115
    s_waitcnt vmcnt(6)
    s_barrier
    v_exp_f32 v84, v84
    v_cvt_pk_bf16_f32 v123, v114, v115
    v_exp_f32 v85, v85
    v_exp_f32 v86, v86
    v_mfma_f32_32x32x16_bf16 v[68:83], v[144:147], v[120:123], v[68:83]
    v_cvt_pk_bf16_f32 v116, v84, v85
    v_exp_f32 v87, v87
    v_exp_f32 v88, v88
    v_cvt_pk_bf16_f32 v117, v86, v87
    v_exp_f32 v89, v89
    v_exp_f32 v90, v90
    v_cvt_pk_bf16_f32 v118, v88, v89
    v_mfma_f32_32x32x16_bf16 v[100:115], v[124:127], v[16:19], v[36:51]
    v_exp_f32 v91, v91
    v_exp_f32 v92, v92
    v_cvt_pk_bf16_f32 v119, v90, v91
    v_exp_f32 v93, v93
    v_exp_f32 v94, v94
    s_waitcnt lgkmcnt(0)
    v_mfma_f32_32x32x16_bf16 v[52:67], v[132:135], v[116:119], v[52:67]
    s_add_u32 m0, m0, 2048
    s_add_u32 s72, s72, 2048
    buffer_load_dwordx4 v1, s[28:31], s72 offen sc1 lds
    v_cvt_pk_bf16_f32 v120, v92, v93
    v_exp_f32 v95, v95
    v_exp_f32 v96, v96
    v_cvt_pk_bf16_f32 v121, v94, v95
    v_exp_f32 v97, v97
    v_exp_f32 v98, v98
    v_cvt_pk_bf16_f32 v122, v96, v97
    v_exp_f32 v99, v99
    v_exp_f32 v100, v100
    v_cvt_pk_bf16_f32 v123, v98, v99
    v_exp_f32 v101, v101
    v_exp_f32 v102, v102
    v_mfma_f32_32x32x16_bf16 v[52:67], v[140:143], v[120:123], v[52:67]
    ds_read_b128 v[124:127], v148 offset:0
    ds_read_b128 v[136:139], v152 offset:3072
    ds_read_b128 v[144:147], v152 offset:3584
    v_cvt_pk_bf16_f32 v116, v100, v101
    v_exp_f32 v103, v103
    v_exp_f32 v104, v104
    v_cvt_pk_bf16_f32 v117, v102, v103
    v_exp_f32 v105, v105
    v_exp_f32 v106, v106
    v_cvt_pk_bf16_f32 v118, v104, v105
    v_mfma_f32_32x32x16_bf16 v[84:99], v[128:131], v[12:15], v[20:35]
    v_exp_f32 v107, v107
    v_exp_f32 v108, v108
    v_cvt_pk_bf16_f32 v119, v106, v107
    v_exp_f32 v109, v109
    v_exp_f32 v110, v110
    v_mfma_f32_32x32x16_bf16 v[68:83], v[132:135], v[116:119], v[68:83]
    s_add_u32 m0, m0, 2048
    s_add_u32 s72, s72, 2048
    buffer_load_dwordx4 v1, s[28:31], s72 offen sc1 lds
    v_cvt_pk_bf16_f32 v120, v108, v109
    v_exp_f32 v111, v111
    v_exp_f32 v112, v112
    v_cvt_pk_bf16_f32 v121, v110, v111
    v_exp_f32 v113, v113
    v_exp_f32 v114, v114
    v_cvt_pk_bf16_f32 v122, v112, v113
    v_exp_f32 v115, v115
    v_exp_f32 v84, v84
    v_cvt_pk_bf16_f32 v123, v114, v115
    v_exp_f32 v85, v85
    v_exp_f32 v86, v86
    v_mfma_f32_32x32x16_bf16 v[68:83], v[140:143], v[120:123], v[68:83]
    v_cvt_pk_bf16_f32 v116, v84, v85
    v_exp_f32 v87, v87
    v_exp_f32 v88, v88
    v_cvt_pk_bf16_f32 v117, v86, v87
    v_exp_f32 v89, v89
    v_exp_f32 v90, v90
    v_cvt_pk_bf16_f32 v118, v88, v89
    v_mfma_f32_32x32x16_bf16 v[100:115], v[128:131], v[16:19], v[36:51]
    v_exp_f32 v91, v91
    v_exp_f32 v92, v92
    v_cvt_pk_bf16_f32 v119, v90, v91
    v_exp_f32 v93, v93
    v_exp_f32 v94, v94
    s_waitcnt lgkmcnt(0)
    v_mfma_f32_32x32x16_bf16 v[52:67], v[136:139], v[116:119], v[52:67]
    s_add_u32 m0, m0, 2048
    s_add_u32 s72, s72, 2048
    buffer_load_dwordx4 v1, s[28:31], s72 offen sc1 lds
    v_cvt_pk_bf16_f32 v120, v92, v93
    v_exp_f32 v95, v95
    v_exp_f32 v96, v96
    v_cvt_pk_bf16_f32 v121, v94, v95
    v_exp_f32 v97, v97
    v_exp_f32 v98, v98
    v_cvt_pk_bf16_f32 v122, v96, v97
    v_exp_f32 v99, v99
    v_exp_f32 v100, v100
    v_cvt_pk_bf16_f32 v123, v98, v99
    v_exp_f32 v101, v101
    v_exp_f32 v102, v102
    v_mfma_f32_32x32x16_bf16 v[52:67], v[144:147], v[120:123], v[52:67]
    ds_read_b128 v[128:131], v148 offset:1024
    ds_read_b128 v[132:135], v153 offset:0
    ds_read_b128 v[140:143], v153 offset:512
    v_cvt_pk_bf16_f32 v116, v100, v101
    v_exp_f32 v103, v103
    v_exp_f32 v104, v104
    v_cvt_pk_bf16_f32 v117, v102, v103
    v_exp_f32 v105, v105
    v_exp_f32 v106, v106
    v_cvt_pk_bf16_f32 v118, v104, v105
    v_mfma_f32_32x32x16_bf16 v[84:99], v[124:127], v[12:15], v[20:35]
    v_exp_f32 v107, v107
    v_exp_f32 v108, v108
    v_cvt_pk_bf16_f32 v119, v106, v107
    v_exp_f32 v109, v109
    v_exp_f32 v110, v110
    v_mfma_f32_32x32x16_bf16 v[68:83], v[136:139], v[116:119], v[68:83]
    s_add_u32 m0, m0, 2048
    s_add_u32 s72, s72, 2048
    buffer_load_dwordx4 v1, s[28:31], s72 offen sc1 lds
    v_cvt_pk_bf16_f32 v120, v108, v109
    v_exp_f32 v111, v111
    v_exp_f32 v112, v112
    v_cvt_pk_bf16_f32 v121, v110, v111
    v_exp_f32 v113, v113
    v_exp_f32 v114, v114
    v_cvt_pk_bf16_f32 v122, v112, v113
    v_exp_f32 v115, v115
    v_exp_f32 v84, v84
    v_cvt_pk_bf16_f32 v123, v114, v115
    v_exp_f32 v85, v85
    v_exp_f32 v86, v86
    v_mfma_f32_32x32x16_bf16 v[68:83], v[144:147], v[120:123], v[68:83]
    v_cvt_pk_bf16_f32 v116, v84, v85
    v_exp_f32 v87, v87
    v_exp_f32 v88, v88
    v_cvt_pk_bf16_f32 v117, v86, v87
    v_exp_f32 v89, v89
    v_exp_f32 v90, v90
    v_cvt_pk_bf16_f32 v118, v88, v89
    v_mfma_f32_32x32x16_bf16 v[100:115], v[124:127], v[16:19], v[36:51]
    v_exp_f32 v91, v91
    v_exp_f32 v92, v92
    v_cvt_pk_bf16_f32 v119, v90, v91
    v_exp_f32 v93, v93
    v_exp_f32 v94, v94
    s_waitcnt lgkmcnt(0)
    v_mfma_f32_32x32x16_bf16 v[52:67], v[132:135], v[116:119], v[52:67]
    s_add_u32 m0, m0, 2048
    s_add_u32 s72, s72, 2048
    buffer_load_dwordx4 v1, s[28:31], s72 offen sc1 lds
    v_cvt_pk_bf16_f32 v120, v92, v93
    v_exp_f32 v95, v95
    v_exp_f32 v96, v96
    v_cvt_pk_bf16_f32 v121, v94, v95
    v_exp_f32 v97, v97
    v_exp_f32 v98, v98
    v_cvt_pk_bf16_f32 v122, v96, v97
    v_exp_f32 v99, v99
    v_exp_f32 v100, v100
    v_cvt_pk_bf16_f32 v123, v98, v99
    v_exp_f32 v101, v101
    v_exp_f32 v102, v102
    v_mfma_f32_32x32x16_bf16 v[52:67], v[140:143], v[120:123], v[52:67]
    ds_read_b128 v[124:127], v148 offset:2048
    ds_read_b128 v[136:139], v153 offset:1024
    ds_read_b128 v[144:147], v153 offset:1536
    v_cvt_pk_bf16_f32 v116, v100, v101
    v_exp_f32 v103, v103
    v_exp_f32 v104, v104
    v_cvt_pk_bf16_f32 v117, v102, v103
    v_exp_f32 v105, v105
    v_exp_f32 v106, v106
    v_cvt_pk_bf16_f32 v118, v104, v105
    v_mfma_f32_32x32x16_bf16 v[84:99], v[128:131], v[12:15], v[20:35]
    v_exp_f32 v107, v107
    v_exp_f32 v108, v108
    v_cvt_pk_bf16_f32 v119, v106, v107
    v_exp_f32 v109, v109
    v_exp_f32 v110, v110
    v_mfma_f32_32x32x16_bf16 v[68:83], v[132:135], v[116:119], v[68:83]
    s_add_u32 m0, m0, 2048
    s_add_u32 s72, s72, 2048
    buffer_load_dwordx4 v1, s[28:31], s72 offen sc1 lds
    v_cvt_pk_bf16_f32 v120, v108, v109
    v_exp_f32 v111, v111
    v_exp_f32 v112, v112
    v_cvt_pk_bf16_f32 v121, v110, v111
    v_exp_f32 v113, v113
    v_exp_f32 v114, v114
    v_cvt_pk_bf16_f32 v122, v112, v113
    v_exp_f32 v115, v115
    v_exp_f32 v84, v84
    v_cvt_pk_bf16_f32 v123, v114, v115
    v_exp_f32 v85, v85
    v_exp_f32 v86, v86
    v_mfma_f32_32x32x16_bf16 v[68:83], v[140:143], v[120:123], v[68:83]
    v_cvt_pk_bf16_f32 v116, v84, v85
    v_exp_f32 v87, v87
    v_exp_f32 v88, v88
    v_cvt_pk_bf16_f32 v117, v86, v87
    v_exp_f32 v89, v89
    v_exp_f32 v90, v90
    v_cvt_pk_bf16_f32 v118, v88, v89
    v_mfma_f32_32x32x16_bf16 v[100:115], v[128:131], v[16:19], v[36:51]
    v_exp_f32 v91, v91
    v_exp_f32 v92, v92
    v_cvt_pk_bf16_f32 v119, v90, v91
    v_exp_f32 v93, v93
    v_exp_f32 v94, v94
    s_waitcnt lgkmcnt(0)
    v_mfma_f32_32x32x16_bf16 v[52:67], v[136:139], v[116:119], v[52:67]
    v_cvt_pk_bf16_f32 v120, v92, v93
    v_exp_f32 v95, v95
    v_exp_f32 v96, v96
    v_cvt_pk_bf16_f32 v121, v94, v95
    v_exp_f32 v97, v97
    v_exp_f32 v98, v98
    v_cvt_pk_bf16_f32 v122, v96, v97
    v_exp_f32 v99, v99
    v_exp_f32 v100, v100
    v_cvt_pk_bf16_f32 v123, v98, v99
    v_exp_f32 v101, v101
    v_exp_f32 v102, v102
    v_mfma_f32_32x32x16_bf16 v[52:67], v[144:147], v[120:123], v[52:67]
    ds_read_b128 v[128:131], v148 offset:3072
    ds_read_b128 v[132:135], v153 offset:2048
    ds_read_b128 v[140:143], v153 offset:2560
    v_cvt_pk_bf16_f32 v116, v100, v101
    v_exp_f32 v103, v103
    v_exp_f32 v104, v104
    v_cvt_pk_bf16_f32 v117, v102, v103
    v_exp_f32 v105, v105
    v_exp_f32 v106, v106
    v_cvt_pk_bf16_f32 v118, v104, v105
    v_mfma_f32_32x32x16_bf16 v[84:99], v[124:127], v[12:15], v[20:35]
    v_exp_f32 v107, v107
    v_exp_f32 v108, v108
    v_cvt_pk_bf16_f32 v119, v106, v107
    v_exp_f32 v109, v109
    v_exp_f32 v110, v110
    v_mfma_f32_32x32x16_bf16 v[68:83], v[136:139], v[116:119], v[68:83]
    v_cvt_pk_bf16_f32 v120, v108, v109
    v_exp_f32 v111, v111
    v_exp_f32 v112, v112
    v_cvt_pk_bf16_f32 v121, v110, v111
    v_exp_f32 v113, v113
    v_exp_f32 v114, v114
    v_cvt_pk_bf16_f32 v122, v112, v113
    v_exp_f32 v115, v115
    s_waitcnt vmcnt(0)
    s_barrier
    v_lshlrev_b32 v250, 6, v0
    s_cmp_ge_u32 s48, 4
    s_cselect_b32 s44, s18, s16
    s_cselect_b32 s45, s19, s17
    s_mov_b32 s46, 1409024
    s_mul_i32 s57, s52, 11
    s_sub_u32 s58, s48, 1
    s_cmp_ge_u32 s48, 4
    s_cselect_b32 s59, 3, 0
    s_sub_u32 s58, s58, s59
    s_lshl_b32 s58, s58, 2
    s_add_u32 s57, s57, s58
    s_cmp_eq_u32 s48, 0
    s_cselect_b32 s44, s12, s44
    s_cselect_b32 s45, s13, s45
    s_cselect_b32 s46, 524288, s46
    s_mov_b32 s47, 0x20000
    s_lshl_b32 s58, s52, 2
    s_cselect_b32 s57, s58, s57
    s_lshl_b32 s57, s57, 12
    s_cmp_eq_u32 s48, 7
    s_cbranch_scc1 L_tw_done
    buffer_load_dword v251, v250, s[44:47], s57 offen
    s_add_u32 s57, s57, 4096
    buffer_load_dword v251, v250, s[44:47], s57 offen
    s_add_u32 s57, s57, 4096
    buffer_load_dword v251, v250, s[44:47], s57 offen
    s_add_u32 s57, s57, 4096
    buffer_load_dword v251, v250, s[44:47], s57 offen
L_tw_done:
    v_exp_f32 v84, v84
    v_cvt_pk_bf16_f32 v123, v114, v115
    v_exp_f32 v85, v85
    v_exp_f32 v86, v86
    v_mfma_f32_32x32x16_bf16 v[68:83], v[144:147], v[120:123], v[68:83]
    v_cvt_pk_bf16_f32 v116, v84, v85
    v_exp_f32 v87, v87
    v_exp_f32 v88, v88
    v_cvt_pk_bf16_f32 v117, v86, v87
    v_exp_f32 v89, v89
    v_exp_f32 v90, v90
    v_cvt_pk_bf16_f32 v118, v88, v89
    v_mfma_f32_32x32x16_bf16 v[100:115], v[124:127], v[16:19], v[36:51]
    v_exp_f32 v91, v91
    v_exp_f32 v92, v92
    v_cvt_pk_bf16_f32 v119, v90, v91
    v_exp_f32 v93, v93
    v_exp_f32 v94, v94
    s_waitcnt lgkmcnt(0)
    v_mfma_f32_32x32x16_bf16 v[52:67], v[132:135], v[116:119], v[52:67]
    v_cvt_pk_bf16_f32 v120, v92, v93
    v_exp_f32 v95, v95
    v_exp_f32 v96, v96
    v_cvt_pk_bf16_f32 v121, v94, v95
    v_exp_f32 v97, v97
    v_exp_f32 v98, v98
    v_cvt_pk_bf16_f32 v122, v96, v97
    v_exp_f32 v99, v99
    v_exp_f32 v100, v100
    v_cvt_pk_bf16_f32 v123, v98, v99
    v_exp_f32 v101, v101
    v_exp_f32 v102, v102
    v_mfma_f32_32x32x16_bf16 v[52:67], v[140:143], v[120:123], v[52:67]
    ds_read_b128 v[124:127], v148 offset:4096
    ds_read_b128 v[136:139], v153 offset:3072
    ds_read_b128 v[144:147], v153 offset:3584
    v_cvt_pk_bf16_f32 v116, v100, v101
    v_exp_f32 v103, v103
    v_exp_f32 v104, v104
    v_cvt_pk_bf16_f32 v117, v102, v103
    v_exp_f32 v105, v105
    v_exp_f32 v106, v106
    v_cvt_pk_bf16_f32 v118, v104, v105
    v_mfma_f32_32x32x16_bf16 v[84:99], v[128:131], v[12:15], v[20:35]
    v_exp_f32 v107, v107
    v_exp_f32 v108, v108
    v_cvt_pk_bf16_f32 v119, v106, v107
    v_exp_f32 v109, v109
    v_exp_f32 v110, v110
    v_mfma_f32_32x32x16_bf16 v[68:83], v[132:135], v[116:119], v[68:83]
    v_cvt_pk_bf16_f32 v120, v108, v109
    v_exp_f32 v111, v111
    v_exp_f32 v112, v112
    v_cvt_pk_bf16_f32 v121, v110, v111
    v_exp_f32 v113, v113
    v_exp_f32 v114, v114
    v_cvt_pk_bf16_f32 v122, v112, v113
    v_exp_f32 v115, v115
    v_exp_f32 v84, v84
    v_cvt_pk_bf16_f32 v123, v114, v115
    v_exp_f32 v85, v85
    v_exp_f32 v86, v86
    v_mfma_f32_32x32x16_bf16 v[68:83], v[140:143], v[120:123], v[68:83]
    v_cvt_pk_bf16_f32 v116, v84, v85
    v_exp_f32 v87, v87
    v_exp_f32 v88, v88
    v_cvt_pk_bf16_f32 v117, v86, v87
    v_exp_f32 v89, v89
    v_exp_f32 v90, v90
    v_cvt_pk_bf16_f32 v118, v88, v89
    v_mfma_f32_32x32x16_bf16 v[100:115], v[128:131], v[16:19], v[36:51]
    v_exp_f32 v91, v91
    v_exp_f32 v92, v92
    v_cvt_pk_bf16_f32 v119, v90, v91
    v_exp_f32 v93, v93
    v_exp_f32 v94, v94
    s_waitcnt lgkmcnt(0)
    v_mfma_f32_32x32x16_bf16 v[52:67], v[136:139], v[116:119], v[52:67]
    v_cvt_pk_bf16_f32 v120, v92, v93
    v_exp_f32 v95, v95
    v_exp_f32 v96, v96
    v_cvt_pk_bf16_f32 v121, v94, v95
    v_exp_f32 v97, v97
    v_exp_f32 v98, v98
    v_cvt_pk_bf16_f32 v122, v96, v97
    v_exp_f32 v99, v99
    v_exp_f32 v100, v100
    v_cvt_pk_bf16_f32 v123, v98, v99
    v_exp_f32 v101, v101
    v_exp_f32 v102, v102
    v_mfma_f32_32x32x16_bf16 v[52:67], v[144:147], v[120:123], v[52:67]
    ds_read_b128 v[128:131], v148 offset:5120
    ds_read_b128 v[132:135], v153 offset:4096
    ds_read_b128 v[140:143], v153 offset:4608
    v_cvt_pk_bf16_f32 v116, v100, v101
    v_exp_f32 v103, v103
    v_exp_f32 v104, v104
    v_cvt_pk_bf16_f32 v117, v102, v103
    v_exp_f32 v105, v105
    v_exp_f32 v106, v106
    v_cvt_pk_bf16_f32 v118, v104, v105
    v_mfma_f32_32x32x16_bf16 v[84:99], v[124:127], v[12:15], v[20:35]
    v_exp_f32 v107, v107
    v_exp_f32 v108, v108
    v_cvt_pk_bf16_f32 v119, v106, v107
    v_exp_f32 v109, v109
    v_exp_f32 v110, v110
    v_mfma_f32_32x32x16_bf16 v[68:83], v[136:139], v[116:119], v[68:83]
    v_cvt_pk_bf16_f32 v120, v108, v109
    v_exp_f32 v111, v111
    v_exp_f32 v112, v112
    v_cvt_pk_bf16_f32 v121, v110, v111
    v_exp_f32 v113, v113
    v_exp_f32 v114, v114
    v_cvt_pk_bf16_f32 v122, v112, v113
    v_exp_f32 v115, v115
    v_add_u32 v148, 4096, v148
    s_mov_b32 s68, 3
L_attn_loop:
    v_exp_f32 v84, v84
    v_cvt_pk_bf16_f32 v123, v114, v115
    v_exp_f32 v85, v85
    v_exp_f32 v86, v86
    v_mfma_f32_32x32x16_bf16 v[68:83], v[144:147], v[120:123], v[68:83]
    v_cvt_pk_bf16_f32 v116, v84, v85
    v_exp_f32 v87, v87
    v_exp_f32 v88, v88
    v_cvt_pk_bf16_f32 v117, v86, v87
    v_exp_f32 v89, v89
    v_exp_f32 v90, v90
    v_cvt_pk_bf16_f32 v118, v88, v89
    v_mfma_f32_32x32x16_bf16 v[100:115], v[124:127], v[16:19], v[36:51]
    v_exp_f32 v91, v91
    v_exp_f32 v92, v92
    v_cvt_pk_bf16_f32 v119, v90, v91
    v_exp_f32 v93, v93
    v_exp_f32 v94, v94
    s_waitcnt lgkmcnt(0)
    v_mfma_f32_32x32x16_bf16 v[52:67], v[132:135], v[116:119], v[52:67]
    v_cvt_pk_bf16_f32 v120, v92, v93
    v_exp_f32 v95, v95
    v_exp_f32 v96, v96
    v_cvt_pk_bf16_f32 v121, v94, v95
    v_exp_f32 v97, v97
    v_exp_f32 v98, v98
    v_cvt_pk_bf16_f32 v122, v96, v97
    v_exp_f32 v99, v99
    v_exp_f32 v100, v100
    v_cvt_pk_bf16_f32 v123, v98, v99
    v_exp_f32 v101, v101
    v_exp_f32 v102, v102
    v_mfma_f32_32x32x16_bf16 v[52:67], v[140:143], v[120:123], v[52:67]
    ds_read_b128 v[124:127], v148 offset:2048
    ds_read_b128 v[136:139], v149 offset:0
    ds_read_b128 v[144:147], v149 offset:512
    v_cvt_pk_bf16_f32 v116, v100, v101
    v_exp_f32 v103, v103
    v_exp_f32 v104, v104
    v_cvt_pk_bf16_f32 v117, v102, v103
    v_exp_f32 v105, v105
    v_exp_f32 v106, v106
    v_cvt_pk_bf16_f32 v118, v104, v105
    v_mfma_f32_32x32x16_bf16 v[84:99], v[128:131], v[12:15], v[20:35]
    v_exp_f32 v107, v107
    v_exp_f32 v108, v108
    v_cvt_pk_bf16_f32 v119, v106, v107
    v_exp_f32 v109, v109
    v_exp_f32 v110, v110
    v_mfma_f32_32x32x16_bf16 v[68:83], v[132:135], v[116:119], v[68:83]
    v_cvt_pk_bf16_f32 v120, v108, v109
    v_exp_f32 v111, v111
    v_exp_f32 v112, v112
    v_cvt_pk_bf16_f32 v121, v110, v111
    v_exp_f32 v113, v113
    v_exp_f32 v114, v114
    v_cvt_pk_bf16_f32 v122, v112, v113
    v_exp_f32 v115, v115
    v_exp_f32 v84, v84
    v_cvt_pk_bf16_f32 v123, v114, v115
    v_exp_f32 v85, v85
    v_exp_f32 v86, v86
    v_mfma_f32_32x32x16_bf16 v[68:83], v[140:143], v[120:123], v[68:83]
    v_cvt_pk_bf16_f32 v116, v84, v85
    v_exp_f32 v87, v87
    v_exp_f32 v88, v88
    v_cvt_pk_bf16_f32 v117, v86, v87
    v_exp_f32 v89, v89
    v_exp_f32 v90, v90
    v_cvt_pk_bf16_f32 v118, v88, v89
    v_mfma_f32_32x32x16_bf16 v[100:115], v[128:131], v[16:19], v[36:51]
    v_exp_f32 v91, v91
    v_exp_f32 v92, v92
    v_cvt_pk_bf16_f32 v119, v90, v91
    v_exp_f32 v93, v93
    v_exp_f32 v94, v94
    s_waitcnt lgkmcnt(0)
    v_mfma_f32_32x32x16_bf16 v[52:67], v[136:139], v[116:119], v[52:67]
    v_cvt_pk_bf16_f32 v120, v92, v93
    v_exp_f32 v95, v95
    v_exp_f32 v96, v96
    v_cvt_pk_bf16_f32 v121, v94, v95
    v_exp_f32 v97, v97
    v_exp_f32 v98, v98
    v_cvt_pk_bf16_f32 v122, v96, v97
    v_exp_f32 v99, v99
    v_exp_f32 v100, v100
    v_cvt_pk_bf16_f32 v123, v98, v99
    v_exp_f32 v101, v101
    v_exp_f32 v102, v102
    v_mfma_f32_32x32x16_bf16 v[52:67], v[144:147], v[120:123], v[52:67]
    ds_read_b128 v[128:131], v148 offset:3072
    ds_read_b128 v[132:135], v149 offset:1024
    ds_read_b128 v[140:143], v149 offset:1536
    v_cvt_pk_bf16_f32 v116, v100, v101
    v_exp_f32 v103, v103
    v_exp_f32 v104, v104
    v_cvt_pk_bf16_f32 v117, v102, v103
    v_exp_f32 v105, v105
    v_exp_f32 v106, v106
    v_cvt_pk_bf16_f32 v118, v104, v105
    v_mfma_f32_32x32x16_bf16 v[84:99], v[124:127], v[12:15], v[20:35]
    v_exp_f32 v107, v107
    v_exp_f32 v108, v108
    v_cvt_pk_bf16_f32 v119, v106, v107
    v_exp_f32 v109, v109
    v_exp_f32 v110, v110
    v_mfma_f32_32x32x16_bf16 v[68:83], v[136:139], v[116:119], v[68:83]
    v_cvt_pk_bf16_f32 v120, v108, v109
    v_exp_f32 v111, v111
    v_exp_f32 v112, v112
    v_cvt_pk_bf16_f32 v121, v110, v111
    v_exp_f32 v113, v113
    v_exp_f32 v114, v114
    v_cvt_pk_bf16_f32 v122, v112, v113
    v_exp_f32 v115, v115
    v_exp_f32 v84, v84
    v_cvt_pk_bf16_f32 v123, v114, v115
    v_exp_f32 v85, v85
    v_exp_f32 v86, v86
    v_mfma_f32_32x32x16_bf16 v[68:83], v[144:147], v[120:123], v[68:83]
    v_cvt_pk_bf16_f32 v116, v84, v85
    v_exp_f32 v87, v87
    v_exp_f32 v88, v88
    v_cvt_pk_bf16_f32 v117, v86, v87
    v_exp_f32 v89, v89
    v_exp_f32 v90, v90
    v_cvt_pk_bf16_f32 v118, v88, v89
    v_mfma_f32_32x32x16_bf16 v[100:115], v[124:127], v[16:19], v[36:51]
    v_exp_f32 v91, v91
    v_exp_f32 v92, v92
    v_cvt_pk_bf16_f32 v119, v90, v91
    v_exp_f32 v93, v93
    v_exp_f32 v94, v94
    s_waitcnt lgkmcnt(0)
    v_mfma_f32_32x32x16_bf16 v[52:67], v[132:135], v[116:119], v[52:67]
    v_cvt_pk_bf16_f32 v120, v92, v93
    v_exp_f32 v95, v95
    v_exp_f32 v96, v96
    v_cvt_pk_bf16_f32 v121, v94, v95
    v_exp_f32 v97, v97
    v_exp_f32 v98, v98
    v_cvt_pk_bf16_f32 v122, v96, v97
    v_exp_f32 v99, v99
    v_exp_f32 v100, v100
    v_cvt_pk_bf16_f32 v123, v98, v99
    v_exp_f32 v101, v101
    v_exp_f32 v102, v102
    v_mfma_f32_32x32x16_bf16 v[52:67], v[140:143], v[120:123], v[52:67]
    ds_read_b128 v[124:127], v148 offset:4096
    ds_read_b128 v[136:139], v149 offset:2048
    ds_read_b128 v[144:147], v149 offset:2560
    v_cvt_pk_bf16_f32 v116, v100, v101
    v_exp_f32 v103, v103
    v_exp_f32 v104, v104
    v_cvt_pk_bf16_f32 v117, v102, v103
    v_exp_f32 v105, v105
    v_exp_f32 v106, v106
    v_cvt_pk_bf16_f32 v118, v104, v105
    v_mfma_f32_32x32x16_bf16 v[84:99], v[128:131], v[12:15], v[20:35]
    v_exp_f32 v107, v107
    v_exp_f32 v108, v108
    v_cvt_pk_bf16_f32 v119, v106, v107
    v_exp_f32 v109, v109
    v_exp_f32 v110, v110
    v_mfma_f32_32x32x16_bf16 v[68:83], v[132:135], v[116:119], v[68:83]
    v_cvt_pk_bf16_f32 v120, v108, v109
    v_exp_f32 v111, v111
    v_exp_f32 v112, v112
    v_cvt_pk_bf16_f32 v121, v110, v111
    v_exp_f32 v113, v113
    v_exp_f32 v114, v114
    v_cvt_pk_bf16_f32 v122, v112, v113
    v_exp_f32 v115, v115
    v_exp_f32 v84, v84
    v_cvt_pk_bf16_f32 v123, v114, v115
    v_exp_f32 v85, v85
    v_exp_f32 v86, v86
    v_mfma_f32_32x32x16_bf16 v[68:83], v[140:143], v[120:123], v[68:83]
    v_cvt_pk_bf16_f32 v116, v84, v85
    v_exp_f32 v87, v87
    v_exp_f32 v88, v88
    v_cvt_pk_bf16_f32 v117, v86, v87
    v_exp_f32 v89, v89
    v_exp_f32 v90, v90
    v_cvt_pk_bf16_f32 v118, v88, v89
    v_mfma_f32_32x32x16_bf16 v[100:115], v[128:131], v[16:19], v[36:51]
    v_exp_f32 v91, v91
    v_exp_f32 v92, v92
    v_cvt_pk_bf16_f32 v119, v90, v91
    v_exp_f32 v93, v93
    v_exp_f32 v94, v94
    s_waitcnt lgkmcnt(0)
    v_mfma_f32_32x32x16_bf16 v[52:67], v[136:139], v[116:119], v[52:67]
    v_cvt_pk_bf16_f32 v120, v92, v93
    v_exp_f32 v95, v95
    v_exp_f32 v96, v96
    v_cvt_pk_bf16_f32 v121, v94, v95
    v_exp_f32 v97, v97
    v_exp_f32 v98, v98
    v_cvt_pk_bf16_f32 v122, v96, v97
    v_exp_f32 v99, v99
    v_exp_f32 v100, v100
    v_cvt_pk_bf16_f32 v123, v98, v99
    v_exp_f32 v101, v101
    v_exp_f32 v102, v102
    v_mfma_f32_32x32x16_bf16 v[52:67], v[144:147], v[120:123], v[52:67]
    ds_read_b128 v[128:131], v148 offset:5120
    ds_read_b128 v[132:135], v149 offset:3072
    ds_read_b128 v[140:143], v149 offset:3584
    v_cvt_pk_bf16_f32 v116, v100, v101
    v_exp_f32 v103, v103
    v_exp_f32 v104, v104
    v_cvt_pk_bf16_f32 v117, v102, v103
    v_exp_f32 v105, v105
    v_exp_f32 v106, v106
    v_cvt_pk_bf16_f32 v118, v104, v105
    v_mfma_f32_32x32x16_bf16 v[84:99], v[124:127], v[12:15], v[20:35]
    v_exp_f32 v107, v107
    v_exp_f32 v108, v108
    v_cvt_pk_bf16_f32 v119, v106, v107
    v_exp_f32 v109, v109
    v_exp_f32 v110, v110
    v_mfma_f32_32x32x16_bf16 v[68:83], v[136:139], v[116:119], v[68:83]
    v_cvt_pk_bf16_f32 v120, v108, v109
    v_exp_f32 v111, v111
    v_exp_f32 v112, v112
    v_cvt_pk_bf16_f32 v121, v110, v111
    v_exp_f32 v113, v113
    v_exp_f32 v114, v114
    v_cvt_pk_bf16_f32 v122, v112, v113
    v_exp_f32 v115, v115
    v_exp_f32 v84, v84
    v_cvt_pk_bf16_f32 v123, v114, v115
    v_exp_f32 v85, v85
    v_exp_f32 v86, v86
    v_mfma_f32_32x32x16_bf16 v[68:83], v[144:147], v[120:123], v[68:83]
    v_cvt_pk_bf16_f32 v116, v84, v85
    v_exp_f32 v87, v87
    v_exp_f32 v88, v88
    v_cvt_pk_bf16_f32 v117, v86, v87
    v_exp_f32 v89, v89
    v_exp_f32 v90, v90
    v_cvt_pk_bf16_f32 v118, v88, v89
    v_mfma_f32_32x32x16_bf16 v[100:115], v[124:127], v[16:19], v[36:51]
    v_exp_f32 v91, v91
    v_exp_f32 v92, v92
    v_cvt_pk_bf16_f32 v119, v90, v91
    v_exp_f32 v93, v93
    v_exp_f32 v94, v94
    s_waitcnt lgkmcnt(0)
    v_mfma_f32_32x32x16_bf16 v[52:67], v[132:135], v[116:119], v[52:67]
    v_cvt_pk_bf16_f32 v120, v92, v93
    v_exp_f32 v95, v95
    v_exp_f32 v96, v96
    v_cvt_pk_bf16_f32 v121, v94, v95
    v_exp_f32 v97, v97
    v_exp_f32 v98, v98
    v_cvt_pk_bf16_f32 v122, v96, v97
    v_exp_f32 v99, v99
    v_exp_f32 v100, v100
    v_cvt_pk_bf16_f32 v123, v98, v99
    v_exp_f32 v101, v101
    v_exp_f32 v102, v102
    v_mfma_f32_32x32x16_bf16 v[52:67], v[140:143], v[120:123], v[52:67]
    ds_read_b128 v[124:127], v148 offset:6144
    ds_read_b128 v[136:139], v150 offset:0
    ds_read_b128 v[144:147], v150 offset:512
    v_cvt_pk_bf16_f32 v116, v100, v101
    v_exp_f32 v103, v103
    v_exp_f32 v104, v104
    v_cvt_pk_bf16_f32 v117, v102, v103
    v_exp_f32 v105, v105
    v_exp_f32 v106, v106
    v_cvt_pk_bf16_f32 v118, v104, v105
    v_mfma_f32_32x32x16_bf16 v[84:99], v[128:131], v[12:15], v[20:35]
    v_exp_f32 v107, v107
    v_exp_f32 v108, v108
    v_cvt_pk_bf16_f32 v119, v106, v107
    v_exp_f32 v109, v109
    v_exp_f32 v110, v110
    v_mfma_f32_32x32x16_bf16 v[68:83], v[132:135], v[116:119], v[68:83]
    v_cvt_pk_bf16_f32 v120, v108, v109
    v_exp_f32 v111, v111
    v_exp_f32 v112, v112
    v_cvt_pk_bf16_f32 v121, v110, v111
    v_exp_f32 v113, v113
    v_exp_f32 v114, v114
    v_cvt_pk_bf16_f32 v122, v112, v113
    v_exp_f32 v115, v115
    v_exp_f32 v84, v84
    v_cvt_pk_bf16_f32 v123, v114, v115
    v_exp_f32 v85, v85
    v_exp_f32 v86, v86
    v_mfma_f32_32x32x16_bf16 v[68:83], v[140:143], v[120:123], v[68:83]
    v_cvt_pk_bf16_f32 v116, v84, v85
    v_exp_f32 v87, v87
    v_exp_f32 v88, v88
    v_cvt_pk_bf16_f32 v117, v86, v87
    v_exp_f32 v89, v89
    v_exp_f32 v90, v90
    v_cvt_pk_bf16_f32 v118, v88, v89
    v_mfma_f32_32x32x16_bf16 v[100:115], v[128:131], v[16:19], v[36:51]
    v_exp_f32 v91, v91
    v_exp_f32 v92, v92
    v_cvt_pk_bf16_f32 v119, v90, v91
    v_exp_f32 v93, v93
    v_exp_f32 v94, v94
    s_waitcnt lgkmcnt(0)
    v_mfma_f32_32x32x16_bf16 v[52:67], v[136:139], v[116:119], v[52:67]
    v_cvt_pk_bf16_f32 v120, v92, v93
    v_exp_f32 v95, v95
    v_exp_f32 v96, v96
    v_cvt_pk_bf16_f32 v121, v94, v95
    v_exp_f32 v97, v97
    v_exp_f32 v98, v98
    v_cvt_pk_bf16_f32 v122, v96, v97
    v_exp_f32 v99, v99
    v_exp_f32 v100, v100
    v_cvt_pk_bf16_f32 v123, v98, v99
    v_exp_f32 v101, v101
    v_exp_f32 v102, v102
    v_mfma_f32_32x32x16_bf16 v[52:67], v[144:147], v[120:123], v[52:67]
    ds_read_b128 v[128:131], v148 offset:7168
    ds_read_b128 v[132:135], v150 offset:1024
    ds_read_b128 v[140:143], v150 offset:1536
    v_cvt_pk_bf16_f32 v116, v100, v101
    v_exp_f32 v103, v103
    v_exp_f32 v104, v104
    v_cvt_pk_bf16_f32 v117, v102, v103
    v_exp_f32 v105, v105
    v_exp_f32 v106, v106
    v_cvt_pk_bf16_f32 v118, v104, v105
    v_mfma_f32_32x32x16_bf16 v[84:99], v[124:127], v[12:15], v[20:35]
    v_exp_f32 v107, v107
    v_exp_f32 v108, v108
    v_cvt_pk_bf16_f32 v119, v106, v107
    v_exp_f32 v109, v109
    v_exp_f32 v110, v110
    v_mfma_f32_32x32x16_bf16 v[68:83], v[136:139], v[116:119], v[68:83]
    v_cvt_pk_bf16_f32 v120, v108, v109
    v_exp_f32 v111, v111
    v_exp_f32 v112, v112
    v_cvt_pk_bf16_f32 v121, v110, v111
    v_exp_f32 v113, v113
    v_exp_f32 v114, v114
    v_cvt_pk_bf16_f32 v122, v112, v113
    v_exp_f32 v115, v115
    v_exp_f32 v84, v84
    v_cvt_pk_bf16_f32 v123, v114, v115
    v_exp_f32 v85, v85
    v_exp_f32 v86, v86
    v_mfma_f32_32x32x16_bf16 v[68:83], v[144:147], v[120:123], v[68:83]
    v_cvt_pk_bf16_f32 v116, v84, v85
    v_exp_f32 v87, v87
    v_exp_f32 v88, v88
    v_cvt_pk_bf16_f32 v117, v86, v87
    v_exp_f32 v89, v89
    v_exp_f32 v90, v90
    v_cvt_pk_bf16_f32 v118, v88, v89
    v_mfma_f32_32x32x16_bf16 v[100:115], v[124:127], v[16:19], v[36:51]
    v_exp_f32 v91, v91
    v_exp_f32 v92, v92
    v_cvt_pk_bf16_f32 v119, v90, v91
    v_exp_f32 v93, v93
    v_exp_f32 v94, v94
    s_waitcnt lgkmcnt(0)
    v_mfma_f32_32x32x16_bf16 v[52:67], v[132:135], v[116:119], v[52:67]
    v_cvt_pk_bf16_f32 v120, v92, v93
    v_exp_f32 v95, v95
    v_exp_f32 v96, v96
    v_cvt_pk_bf16_f32 v121, v94, v95
    v_exp_f32 v97, v97
    v_exp_f32 v98, v98
    v_cvt_pk_bf16_f32 v122, v96, v97
    v_exp_f32 v99, v99
    v_exp_f32 v100, v100
    v_cvt_pk_bf16_f32 v123, v98, v99
    v_exp_f32 v101, v101
    v_exp_f32 v102, v102
    v_mfma_f32_32x32x16_bf16 v[52:67], v[140:143], v[120:123], v[52:67]
    ds_read_b128 v[124:127], v148 offset:8192
    ds_read_b128 v[136:139], v150 offset:2048
    ds_read_b128 v[144:147], v150 offset:2560
    v_cvt_pk_bf16_f32 v116, v100, v101
    v_exp_f32 v103, v103
    v_exp_f32 v104, v104
    v_cvt_pk_bf16_f32 v117, v102, v103
    v_exp_f32 v105, v105
    v_exp_f32 v106, v106
    v_cvt_pk_bf16_f32 v118, v104, v105
    v_mfma_f32_32x32x16_bf16 v[84:99], v[128:131], v[12:15], v[20:35]
    v_exp_f32 v107, v107
    v_exp_f32 v108, v108
    v_cvt_pk_bf16_f32 v119, v106, v107
    v_exp_f32 v109, v109
    v_exp_f32 v110, v110
    v_mfma_f32_32x32x16_bf16 v[68:83], v[132:135], v[116:119], v[68:83]
    v_cvt_pk_bf16_f32 v120, v108, v109
    v_exp_f32 v111, v111
    v_exp_f32 v112, v112
    v_cvt_pk_bf16_f32 v121, v110, v111
    v_exp_f32 v113, v113
    v_exp_f32 v114, v114
    v_cvt_pk_bf16_f32 v122, v112, v113
    v_exp_f32 v115, v115
    v_exp_f32 v84, v84
    v_cvt_pk_bf16_f32 v123, v114, v115
    v_exp_f32 v85, v85
    v_exp_f32 v86, v86
    v_mfma_f32_32x32x16_bf16 v[68:83], v[140:143], v[120:123], v[68:83]
    v_cvt_pk_bf16_f32 v116, v84, v85
    v_exp_f32 v87, v87
    v_exp_f32 v88, v88
    v_cvt_pk_bf16_f32 v117, v86, v87
    v_exp_f32 v89, v89
    v_exp_f32 v90, v90
    v_cvt_pk_bf16_f32 v118, v88, v89
    v_mfma_f32_32x32x16_bf16 v[100:115], v[128:131], v[16:19], v[36:51]
    v_exp_f32 v91, v91
    v_exp_f32 v92, v92
    v_cvt_pk_bf16_f32 v119, v90, v91
    v_exp_f32 v93, v93
    v_exp_f32 v94, v94
    s_waitcnt lgkmcnt(0)
    v_mfma_f32_32x32x16_bf16 v[52:67], v[136:139], v[116:119], v[52:67]
    v_cvt_pk_bf16_f32 v120, v92, v93
    v_exp_f32 v95, v95
    v_exp_f32 v96, v96
    v_cvt_pk_bf16_f32 v121, v94, v95
    v_exp_f32 v97, v97
    v_exp_f32 v98, v98
    v_cvt_pk_bf16_f32 v122, v96, v97
    v_exp_f32 v99, v99
    v_exp_f32 v100, v100
    v_cvt_pk_bf16_f32 v123, v98, v99
    v_exp_f32 v101, v101
    v_exp_f32 v102, v102
    v_mfma_f32_32x32x16_bf16 v[52:67], v[144:147], v[120:123], v[52:67]
    ds_read_b128 v[128:131], v148 offset:9216
    ds_read_b128 v[132:135], v150 offset:3072
    ds_read_b128 v[140:143], v150 offset:3584
    v_cvt_pk_bf16_f32 v116, v100, v101
    v_exp_f32 v103, v103
    v_exp_f32 v104, v104
    v_cvt_pk_bf16_f32 v117, v102, v103
    v_exp_f32 v105, v105
    v_exp_f32 v106, v106
    v_cvt_pk_bf16_f32 v118, v104, v105
    v_mfma_f32_32x32x16_bf16 v[84:99], v[124:127], v[12:15], v[20:35]
    v_exp_f32 v107, v107
    v_exp_f32 v108, v108
    v_cvt_pk_bf16_f32 v119, v106, v107
    v_exp_f32 v109, v109
    v_exp_f32 v110, v110
    v_mfma_f32_32x32x16_bf16 v[68:83], v[136:139], v[116:119], v[68:83]
    v_cvt_pk_bf16_f32 v120, v108, v109
    v_exp_f32 v111, v111
    v_exp_f32 v112, v112
    v_cvt_pk_bf16_f32 v121, v110, v111
    v_exp_f32 v113, v113
    v_exp_f32 v114, v114
    v_cvt_pk_bf16_f32 v122, v112, v113
    v_exp_f32 v115, v115
    v_add_u32 v148, 8192, v148
    v_add_u32 v149, v154, v149
    v_add_u32 v150, v154, v150
    s_cmp_eq_u32 s68, 2
    s_cbranch_scc0 L_attn_nb
    s_cmp_eq_u32 s56, 1
    s_cbranch_scc0 L_attn_nb
    v_mov_b32 v180, 163088
    s_mov_b32 s70, 400000
L_g0done_13:
    ds_read_b32 v181, v180
    s_sub_u32 s70, s70, 1
    s_cbranch_scc1 L_g0done_13_x
    s_waitcnt lgkmcnt(0)
    v_readfirstlane_b32 s63, v181
    s_cmp_ge_u32 s63, 4
    s_cbranch_scc0 L_g0done_13
L_g0done_13_x:
    s_waitcnt lgkmcnt(0)
    s_lshl_b32 s57, s76, 12
    s_add_u32 s57, s57, 122880
    v_add_u32 v180, s57, v1
    v_and_b32 v181, 31, v0
    v_lshlrev_b32 v181, 2, v181
    s_lshl_b32 s57, s76, 9
    s_add_u32 s57, s57, 160768
    v_add_u32 v181, s57, v181
    ds_read_b32 v160, v181
    ds_read_b32 v161, v181 offset:128
    ds_read_b32 v162, v181 offset:256
    ds_read_b32 v163, v181 offset:384
    ds_read_b128 v[164:167], v180 offset:0
    ds_read_b128 v[168:171], v180 offset:1024
    ds_read_b128 v[172:175], v180 offset:2048
    ds_read_b128 v[176:179], v180 offset:3072
    v_and_b32 v184, 31, v0
    v_lshlrev_b32 v184, 3, v184
    s_lshl_b32 s57, s51, 8
    s_add_u32 s57, s57, 204800
    buffer_load_dwordx2 v[182:183], v184, s[28:31], s57 offen sc1
L_attn_nb:
    s_sub_u32 s68, s68, 1
    s_cmp_lg_u32 s68, 0
    s_cbranch_scc1 L_attn_loop
    v_cvt_pk_bf16_f32 v123, v114, v115
    s_nop 1
    v_mfma_f32_32x32x16_bf16 v[68:83], v[144:147], v[120:123], v[68:83]
    s_setprio 0
    s_cmp_eq_u32 s56, 1
    s_cbranch_scc1 L_g1_post
    s_lshl_b32 s57, s76, 12
    s_add_u32 s57, s57, 122880
    v_add_u32 v157, s57, v1
    v_and_b32 v158, 31, v0
    v_lshlrev_b32 v158, 2, v158
    s_lshl_b32 s57, s76, 9
    s_add_u32 s57, s57, 160768
    v_add_u32 v158, s57, v158
    s_nop 4
    ds_write_b128 v157, v[52:55]
    ds_write_b128 v157, v[56:59] offset:1024
    ds_write_b32 v158, v60
    ds_write_b32 v158, v155 offset:128
    s_nop 3
    ds_write_b128 v157, v[68:71] offset:2048
    ds_write_b128 v157, v[72:75] offset:3072
    ds_write_b32 v158, v76 offset:256
    ds_write_b32 v158, v156 offset:384
    v_mov_b32 v159, 163088
    v_mov_b32 v160, 1
    s_waitcnt lgkmcnt(0)
    s_mov_b64 exec, 1
    ds_add_u32 v159, v160
    s_mov_b64 exec, -1
    s_mov_b32 s70, 400000
L_g0all_14:
    ds_read_b32 v160, v159
    s_sub_u32 s70, s70, 1
    s_cbranch_scc1 L_g0all_14_x
    s_waitcnt lgkmcnt(0)
    v_readfirstlane_b32 s63, v160
    s_cmp_ge_u32 s63, 4
    s_cbranch_scc0 L_g0all_14
L_g0all_14_x:
    s_waitcnt lgkmcnt(0)
    v_and_b32 v172, 31, v0
    v_lshlrev_b32 v172, 3, v172
    s_lshl_b32 s57, s51, 8
    s_add_u32 s57, s57, 204800
    buffer_load_dwordx2 v[174:175], v172, s[28:31], s57 offen sc1
    v_and_b32 v176, 15, v0
    v_lshlrev_b32 v176, 7, v176
    v_bfe_u32 v177, v0, 4, 1
    v_mul_u32_u24 v177, 16384, v177
    s_lshl_b32 s57, s51, 11
    s_add_u32 s57, s57, 139264
    v_add3_u32 v176, v176, v177, s57
    v_and_b32 v177, 31, v0
    v_lshlrev_b32 v177, 7, v177
    s_lshl_b32 s57, s51, 12
    s_add_u32 s57, s57, 172032
    v_add_u32 v177, s57, v177
    v_cndmask_b32 v176, v176, v177, s[64:65]
    buffer_load_dword v251, v176, s[28:31], 0 offen sc1
    s_mov_b32 s36, s12
    s_mov_b32 s37, s13
    s_mov_b32 s38, 524288
    s_mov_b32 s39, 0x20000
    s_lshl_b32 s72, s76, 17
    s_lshl_b32 s57, s50, 7
    s_add_u32 s72, s72, s57
    s_lshl_b32 s60, s76, 14
    s_add_u32 m0, s60, 0
    s_nop 0
    s_waitcnt vmcnt(7)
    buffer_load_dwordx4 v2, s[36:39], s72 offen lds
    s_add_u32 m0, m0, 1024
    s_add_u32 s72, s72, 8192
    s_waitcnt vmcnt(7)
    buffer_load_dwordx4 v2, s[36:39], s72 offen lds
    s_add_u32 m0, m0, 1024
    s_add_u32 s72, s72, 8192
    s_waitcnt vmcnt(7)
    buffer_load_dwordx4 v2, s[36:39], s72 offen lds
    s_add_u32 m0, m0, 1024
    s_add_u32 s72, s72, 8192
    s_waitcnt vmcnt(7)
    buffer_load_dwordx4 v2, s[36:39], s72 offen lds
    s_add_u32 m0, m0, 1024
    s_add_u32 s72, s72, 8192
    s_waitcnt vmcnt(7)
    buffer_load_dwordx4 v2, s[36:39], s72 offen lds
    s_add_u32 m0, m0, 1024
    s_add_u32 s72, s72, 8192
    s_waitcnt vmcnt(7)
    buffer_load_dwordx4 v2, s[36:39], s72 offen lds
    s_add_u32 m0, m0, 1024
    s_add_u32 s72, s72, 8192
    s_waitcnt vmcnt(7)
    buffer_load_dwordx4 v2, s[36:39], s72 offen lds
    s_add_u32 m0, m0, 1024
    s_add_u32 s72, s72, 8192
    s_waitcnt vmcnt(7)
    buffer_load_dwordx4 v2, s[36:39], s72 offen lds
    s_add_u32 m0, m0, 1024
    s_add_u32 s72, s72, 8192
    s_waitcnt vmcnt(7)
    buffer_load_dwordx4 v2, s[36:39], s72 offen lds
    s_add_u32 m0, m0, 1024
    s_add_u32 s72, s72, 8192
    s_waitcnt vmcnt(7)
    buffer_load_dwordx4 v2, s[36:39], s72 offen lds
    s_add_u32 m0, m0, 1024
    s_add_u32 s72, s72, 8192
    s_waitcnt vmcnt(7)
    buffer_load_dwordx4 v2, s[36:39], s72 offen lds
    s_add_u32 m0, m0, 1024
    s_add_u32 s72, s72, 8192
    s_waitcnt vmcnt(7)
    buffer_load_dwordx4 v2, s[36:39], s72 offen lds
    s_add_u32 m0, m0, 1024
    s_add_u32 s72, s72, 8192
    s_waitcnt vmcnt(7)
    buffer_load_dwordx4 v2, s[36:39], s72 offen lds
    s_add_u32 m0, m0, 1024
    s_add_u32 s72, s72, 8192
    s_waitcnt vmcnt(7)
    buffer_load_dwordx4 v2, s[36:39], s72 offen lds
    s_add_u32 m0, m0, 1024
    s_add_u32 s72, s72, 8192
    s_waitcnt vmcnt(7)
    buffer_load_dwordx4 v2, s[36:39], s72 offen lds
    s_add_u32 m0, m0, 1024
    s_add_u32 s72, s72, 8192
    s_waitcnt vmcnt(7)
    buffer_load_dwordx4 v2, s[36:39], s72 offen lds
    s_mov_b32 s36, s20
    s_mov_b32 s37, s21
    s_mov_b32 s38, 1409024
    s_mov_b32 s39, 0x20000
    v_add_u32 v179, 0, v0
    v_mul_u32_u24 v180, 171, v179
    v_lshrrev_b32 v180, 10, v180
    v_mul_u32_u24 v181, 6, v180
    v_sub_u32 v179, v179, v181
    v_mul_u32_u24 v181, 192, v180
    v_mul_u32_u24 v180, 2752, v180
    v_lshl_add_u32 v184, v179, 4, v181
    v_lshl_add_u32 v176, v179, 4, v180
    v_add_u32 v179, 64, v0
    v_mul_u32_u24 v180, 171, v179
    v_lshrrev_b32 v180, 10, v180
    v_mul_u32_u24 v181, 6, v180
    v_sub_u32 v179, v179, v181
    v_mul_u32_u24 v181, 192, v180
    v_mul_u32_u24 v180, 2752, v180
    v_lshl_add_u32 v185, v179, 4, v181
    v_lshl_add_u32 v177, v179, 4, v180
    v_add_u32 v179, 128, v0
    v_mul_u32_u24 v180, 171, v179
    v_lshrrev_b32 v180, 10, v180
    v_mul_u32_u24 v181, 6, v180
    v_sub_u32 v179, v179, v181
    v_mul_u32_u24 v181, 192, v180
    v_mul_u32_u24 v180, 2752, v180
    v_lshl_add_u32 v186, v179, 4, v181
    v_lshl_add_u32 v178, v179, 4, v180
    s_cmp_lt_u32 s52, 29
    s_cselect_b32 s77, 1, 0
    s_mul_i32 s62, s52, 3
    s_min_u32 s62, s62, 83
    s_lshl_b32 s73, s62, 5
    s_mov_b32 s40, s16
    s_mov_b32 s41, s17
    s_mov_b32 s42, 1409024
    s_mov_b32 s43, 0x20000
    s_mov_b32 s44, s18
    s_mov_b32 s45, s19
    s_mov_b32 s46, 1409024
    s_mov_b32 s47, 0x20000
    s_mul_i32 s57, s76, 352256
    s_add_u32 s57, s57, s73
    s_cmp_eq_u32 s77, 0
    s_cbranch_scc1 L_g0_nogu
    s_waitcnt vmcnt(7)
    buffer_load_dwordx4 v[76:79], v176, s[40:43], s57 offen
    s_waitcnt vmcnt(7)
    buffer_load_dwordx4 v[80:83], v176, s[44:47], s57 offen
    s_waitcnt vmcnt(7)
    buffer_load_dwordx4 v[84:87], v177, s[40:43], s57 offen
    s_waitcnt vmcnt(7)
    buffer_load_dwordx4 v[88:91], v177, s[44:47], s57 offen
    s_waitcnt vmcnt(7)
    buffer_load_dwordx4 v[92:95], v178, s[40:43], s57 offen
    s_waitcnt vmcnt(7)
    buffer_load_dwordx4 v[96:99], v178, s[44:47], s57 offen
    s_add_u32 s57, s57, 88064
    s_waitcnt vmcnt(7)
    buffer_load_dwordx4 v[100:103], v176, s[40:43], s57 offen
    s_waitcnt vmcnt(7)
    buffer_load_dwordx4 v[104:107], v176, s[44:47], s57 offen
    s_waitcnt vmcnt(7)
    buffer_load_dwordx4 v[108:111], v177, s[40:43], s57 offen
    s_waitcnt vmcnt(7)
    buffer_load_dwordx4 v[112:115], v177, s[44:47], s57 offen
    s_waitcnt vmcnt(7)
    buffer_load_dwordx4 v[116:119], v178, s[40:43], s57 offen
    s_waitcnt vmcnt(7)
    buffer_load_dwordx4 v[120:123], v178, s[44:47], s57 offen
    s_add_u32 s57, s57, 88064
    s_waitcnt vmcnt(7)
    buffer_load_dwordx4 v[124:127], v176, s[40:43], s57 offen
    s_waitcnt vmcnt(7)
    buffer_load_dwordx4 v[128:131], v176, s[44:47], s57 offen
    s_waitcnt vmcnt(7)
    buffer_load_dwordx4 v[132:135], v177, s[40:43], s57 offen
    s_waitcnt vmcnt(7)
    buffer_load_dwordx4 v[136:139], v177, s[44:47], s57 offen
    s_waitcnt vmcnt(7)
    buffer_load_dwordx4 v[140:143], v178, s[40:43], s57 offen
    s_waitcnt vmcnt(7)
    buffer_load_dwordx4 v[144:147], v178, s[44:47], s57 offen
    s_add_u32 s57, s57, 88064
    s_waitcnt vmcnt(7)
    buffer_load_dwordx4 v[148:151], v176, s[40:43], s57 offen
    s_waitcnt vmcnt(7)
    buffer_load_dwordx4 v[152:155], v176, s[44:47], s57 offen
    s_waitcnt vmcnt(7)
    buffer_load_dwordx4 v[156:159], v177, s[40:43], s57 offen
    s_waitcnt vmcnt(7)
    buffer_load_dwordx4 v[160:163], v177, s[44:47], s57 offen
    s_waitcnt vmcnt(7)
    buffer_load_dwordx4 v[164:167], v178, s[40:43], s57 offen
    s_waitcnt vmcnt(7)
    buffer_load_dwordx4 v[168:171], v178, s[44:47], s57 offen
L_g0_nogu:
    s_mul_i32 s57, s52, 11
    s_mul_i32 s58, s76, 3
    s_add_u32 s57, s57, s58
    s_lshl_b32 s57, s57, 12
    buffer_load_dword v251, v250, s[36:39], s57 offen
    s_add_u32 s57, s57, 4096
    buffer_load_dword v251, v250, s[36:39], s57 offen
    s_add_u32 s57, s57, 4096
    buffer_load_dword v251, v250, s[36:39], s57 offen
    v_and_b32 v240, 15, v0
    v_lshrrev_b32 v12, 2, v240
    v_lshrrev_b32 v241, 5, v0
    v_mul_u32_u24 v241, 4, v241
    v_add_u32 v12, v12, v241
    v_lshlrev_b32 v12, 7, v12
    v_and_b32 v241, 3, v240
    v_lshlrev_b32 v241, 3, v241
    v_and_b32 v240, 8, v240
    v_lshlrev_b32 v240, 3, v240
    s_lshl_b32 s57, s55, 6
    v_xor_b32 v240, s57, v240
    v_add_u32 v240, v240, v241
    v_and_b32 v241, 16, v0
    v_lshl_add_u32 v240, v241, 1, v240
    v_add_u32 v12, v12, v240
    v_add_u32 v12, 0, v12
    v_xor_b32 v13, 64, v12
    s_lshl_b32 s57, s55, 15
    v_add_u32 v12, s57, v12
    v_add_u32 v13, s57, v13
    v_and_b32 v14, 7, v0
    v_lshlrev_b32 v14, 4, v14
    s_lshl_b32 s57, s67, 8
    s_lshl_b32 s58, s55, 7
    s_add_u32 s57, s57, s58
    s_add_u32 s57, s57, 139264
    v_add_u32 v14, s57, v14
    s_mul_i32 s57, s76, 24576
    s_add_u32 s57, s57, 65536
    v_add_u32 v184, s57, v184
    v_add_u32 v185, s57, v185
    v_add_u32 v186, s57, v186
    s_waitcnt vmcnt(3)
    v_cmp_eq_u32 vcc, s53, v174
    v_cmp_eq_u32 s[74:75], s83, v175
    s_nop 1
    s_and_b64 vcc, vcc, s[74:75]
    s_cmp_eq_u64 vcc, -1
    s_cselect_b32 s82, 1, 0
    s_barrier
    s_cmp_eq_u32 s77, 0
    s_cbranch_scc1 L_g0_noguw
    ds_write_b128 v184, v[76:79] offset:0
    ds_write_b128 v184, v[80:83] offset:96
    ds_write_b128 v185, v[84:87] offset:0
    ds_write_b128 v185, v[88:91] offset:96
    ds_write_b128 v186, v[92:95] offset:0
    ds_write_b128 v186, v[96:99] offset:96
    ds_write_b128 v184, v[100:103] offset:6144
    ds_write_b128 v184, v[104:107] offset:6240
    ds_write_b128 v185, v[108:111] offset:6144
    ds_write_b128 v185, v[112:115] offset:6240
    ds_write_b128 v186, v[116:119] offset:6144
    ds_write_b128 v186, v[120:123] offset:6240
    ds_write_b128 v184, v[124:127] offset:12288
    ds_write_b128 v184, v[128:131] offset:12384
    ds_write_b128 v185, v[132:135] offset:12288
    ds_write_b128 v185, v[136:139] offset:12384
    ds_write_b128 v186, v[140:143] offset:12288
    ds_write_b128 v186, v[144:147] offset:12384
    ds_write_b128 v184, v[148:151] offset:18432
    ds_write_b128 v184, v[152:155] offset:18528
    ds_write_b128 v185, v[156:159] offset:18432
    ds_write_b128 v185, v[160:163] offset:18528
    ds_write_b128 v186, v[164:167] offset:18432
    ds_write_b128 v186, v[168:171] offset:18528
L_g0_noguw:
    s_lshl_b32 s57, s76, 12
    s_add_u32 s57, s57, 0
    v_add_u32 v246, s57, v1
    s_xor_b32 s57, s57, 4096
    v_add_u32 v247, s57, v1
    s_lshl_b32 s72, s67, 15
    s_lshl_b32 s57, s55, 14
    s_add_u32 s72, s72, s57
    s_add_u32 s72, s72, 1048576
    s_mov_b32 s70, 400000
    buffer_load_dword v15, v14, s[28:31], 0 offen offset:0 sc1
L_fo_15:
    s_waitcnt vmcnt(0)
    v_cmp_ne_u32 vcc, s53, v15
    s_cbranch_vccz L_fo_15_x
    s_sub_u32 s70, s70, 1
    s_cbranch_scc1 L_fo_15_x
    buffer_load_dword v15, v14, s[28:31], 0 offen offset:0 sc1
    s_branch L_fo_15
L_fo_15_x:
    s_waitcnt lgkmcnt(0)
    buffer_load_dwordx4 v[76:79], v1, s[28:31], s72 offen offset:0 sc1
    buffer_load_dwordx4 v[80:83], v1, s[28:31], s72 offen offset:1024 sc1
    buffer_load_dwordx4 v[84:87], v1, s[28:31], s72 offen offset:2048 sc1
    buffer_load_dwordx4 v[88:91], v1, s[28:31], s72 offen offset:3072 sc1
    s_add_u32 s72, s72, 4096
    buffer_load_dwordx4 v[92:95], v1, s[28:31], s72 offen offset:0 sc1
    buffer_load_dwordx4 v[96:99], v1, s[28:31], s72 offen offset:1024 sc1
    buffer_load_dwordx4 v[100:103], v1, s[28:31], s72 offen offset:2048 sc1
    buffer_load_dwordx4 v[104:107], v1, s[28:31], s72 offen offset:3072 sc1
    s_add_u32 s72, s72, 4096
    buffer_load_dwordx4 v[108:111], v1, s[28:31], s72 offen offset:0 sc1
    buffer_load_dwordx4 v[112:115], v1, s[28:31], s72 offen offset:1024 sc1
    buffer_load_dwordx4 v[116:119], v1, s[28:31], s72 offen offset:2048 sc1
    buffer_load_dwordx4 v[120:123], v1, s[28:31], s72 offen offset:3072 sc1
    v_lshlrev_b32 v140, 16, v4
    v_and_b32 v141, 0xffff0000, v4
    v_lshlrev_b32 v142, 16, v5
    v_and_b32 v143, 0xffff0000, v5
    v_lshlrev_b32 v144, 16, v6
    v_and_b32 v145, 0xffff0000, v6
    v_lshlrev_b32 v146, 16, v7
    v_and_b32 v147, 0xffff0000, v7
    v_lshlrev_b32 v148, 16, v8
    v_and_b32 v149, 0xffff0000, v8
    v_lshlrev_b32 v150, 16, v9
    v_and_b32 v151, 0xffff0000, v9
    v_lshlrev_b32 v152, 16, v10
    v_and_b32 v153, 0xffff0000, v10
    v_lshlrev_b32 v154, 16, v11
    v_and_b32 v155, 0xffff0000, v11
    ds_read_b64_tr_b16 v[172:173], v12 offset:0
    ds_read_b64_tr_b16 v[174:175], v12 offset:1024
    ds_read_b64_tr_b16 v[176:177], v13 offset:0
    ds_read_b64_tr_b16 v[178:179], v13 offset:1024
    ds_read_b64_tr_b16 v[180:181], v12 offset:2048
    ds_read_b64_tr_b16 v[182:183], v12 offset:3072
    ds_read_b64_tr_b16 v[184:185], v13 offset:2048
    ds_read_b64_tr_b16 v[186:187], v13 offset:3072
    s_waitcnt vmcnt(11) lgkmcnt(4)
    v_mfma_f32_32x32x16_bf16 v[140:155], v[172:175], v[76:79], v[140:155]
    ds_read_b64_tr_b16 v[188:189], v12 offset:4096
    ds_read_b64_tr_b16 v[190:191], v12 offset:5120
    ds_read_b64_tr_b16 v[192:193], v13 offset:4096
    ds_read_b64_tr_b16 v[194:195], v13 offset:5120
    v_mfma_f32_32x32x16_bf16 v[156:171], v[176:179], v[76:79], 0
    s_add_u32 s72, s72, 4096
    buffer_load_dwordx4 v[124:127], v1, s[28:31], s72 offen offset:0 sc1
    s_waitcnt vmcnt(11) lgkmcnt(4)
    v_mfma_f32_32x32x16_bf16 v[140:155], v[180:183], v[80:83], v[140:155]
    ds_read_b64_tr_b16 v[172:173], v12 offset:6144
    ds_read_b64_tr_b16 v[174:175], v12 offset:7168
    ds_read_b64_tr_b16 v[176:177], v13 offset:6144
    ds_read_b64_tr_b16 v[178:179], v13 offset:7168
    v_mfma_f32_32x32x16_bf16 v[156:171], v[184:187], v[80:83], v[156:171]
    buffer_load_dwordx4 v[128:131], v1, s[28:31], s72 offen offset:1024 sc1
    s_waitcnt vmcnt(11) lgkmcnt(4)
    v_mfma_f32_32x32x16_bf16 v[140:155], v[188:191], v[84:87], v[140:155]
    ds_read_b64_tr_b16 v[180:181], v12 offset:8192
    ds_read_b64_tr_b16 v[182:183], v12 offset:9216
    ds_read_b64_tr_b16 v[184:185], v13 offset:8192
    ds_read_b64_tr_b16 v[186:187], v13 offset:9216
    v_mfma_f32_32x32x16_bf16 v[156:171], v[192:195], v[84:87], v[156:171]
    buffer_load_dwordx4 v[132:135], v1, s[28:31], s72 offen offset:2048 sc1
    s_waitcnt vmcnt(11) lgkmcnt(4)
    v_mfma_f32_32x32x16_bf16 v[140:155], v[172:175], v[88:91], v[140:155]
    ds_read_b64_tr_b16 v[188:189], v12 offset:10240
    ds_read_b64_tr_b16 v[190:191], v12 offset:11264
    ds_read_b64_tr_b16 v[192:193], v13 offset:10240
    ds_read_b64_tr_b16 v[194:195], v13 offset:11264
    v_mfma_f32_32x32x16_bf16 v[156:171], v[176:179], v[88:91], v[156:171]
    buffer_load_dwordx4 v[136:139], v1, s[28:31], s72 offen offset:3072 sc1
    s_waitcnt vmcnt(11) lgkmcnt(4)
    v_mfma_f32_32x32x16_bf16 v[140:155], v[180:183], v[92:95], v[140:155]
    ds_read_b64_tr_b16 v[172:173], v12 offset:12288
    ds_read_b64_tr_b16 v[174:175], v12 offset:13312
    ds_read_b64_tr_b16 v[176:177], v13 offset:12288
    ds_read_b64_tr_b16 v[178:179], v13 offset:13312
    v_mfma_f32_32x32x16_bf16 v[156:171], v[184:187], v[92:95], v[156:171]
    s_waitcnt vmcnt(10) lgkmcnt(4)
    v_mfma_f32_32x32x16_bf16 v[140:155], v[188:191], v[96:99], v[140:155]
    ds_read_b64_tr_b16 v[180:181], v12 offset:14336
    ds_read_b64_tr_b16 v[182:183], v12 offset:15360
    ds_read_b64_tr_b16 v[184:185], v13 offset:14336
    ds_read_b64_tr_b16 v[186:187], v13 offset:15360
    v_mfma_f32_32x32x16_bf16 v[156:171], v[192:195], v[96:99], v[156:171]
    s_waitcnt vmcnt(9) lgkmcnt(4)
    v_mfma_f32_32x32x16_bf16 v[140:155], v[172:175], v[100:103], v[140:155]
    ds_read_b64_tr_b16 v[188:189], v12 offset:16384
    ds_read_b64_tr_b16 v[190:191], v12 offset:17408
    ds_read_b64_tr_b16 v[192:193], v13 offset:16384
    ds_read_b64_tr_b16 v[194:195], v13 offset:17408
    v_mfma_f32_32x32x16_bf16 v[156:171], v[176:179], v[100:103], v[156:171]
    s_lshl_b32 s72, s67, 15
    s_lshl_b32 s57, s50, 12
    s_lshl_b32 s58, s55, 11
    s_add_u32 s72, s72, s57
    s_add_u32 s72, s72, s58
    s_add_u32 s72, s72, 3145728
    s_waitcnt vmcnt(8) lgkmcnt(4)
    v_mfma_f32_32x32x16_bf16 v[140:155], v[180:183], v[104:107], v[140:155]
    ds_read_b64_tr_b16 v[172:173], v12 offset:18432
    ds_read_b64_tr_b16 v[174:175], v12 offset:19456
    ds_read_b64_tr_b16 v[176:177], v13 offset:18432
    ds_read_b64_tr_b16 v[178:179], v13 offset:19456
    v_mfma_f32_32x32x16_bf16 v[156:171], v[184:187], v[104:107], v[156:171]
    s_lshl_b32 s57, s50, 1
    s_add_u32 s57, s57, s55
    s_lshl_b32 s78, s57, 8
    s_lshl_b32 s59, s67, 12
    s_add_u32 s78, s78, s59
    s_add_u32 s78, s78, 262144
    v_lshlrev_b32 v248, 2, v0
    s_waitcnt vmcnt(7) lgkmcnt(4)
    v_mfma_f32_32x32x16_bf16 v[140:155], v[188:191], v[108:111], v[140:155]
    ds_read_b64_tr_b16 v[180:181], v12 offset:20480
    ds_read_b64_tr_b16 v[182:183], v12 offset:21504
    ds_read_b64_tr_b16 v[184:185], v13 offset:20480
    ds_read_b64_tr_b16 v[186:187], v13 offset:21504
    v_mfma_f32_32x32x16_bf16 v[156:171], v[192:195], v[108:111], v[156:171]
    s_waitcnt vmcnt(6) lgkmcnt(4)
    v_mfma_f32_32x32x16_bf16 v[140:155], v[172:175], v[112:115], v[140:155]
    ds_read_b64_tr_b16 v[188:189], v12 offset:22528
    ds_read_b64_tr_b16 v[190:191], v12 offset:23552
    ds_read_b64_tr_b16 v[192:193], v13 offset:22528
    ds_read_b64_tr_b16 v[194:195], v13 offset:23552
    v_mfma_f32_32x32x16_bf16 v[156:171], v[176:179], v[112:115], v[156:171]
    s_lshl_b32 s57, s57, 4
    s_lshl_b32 s59, s67, 8
    s_add_u32 s57, s57, s59
    s_add_u32 s57, s57, 155648
    v_mov_b32 v249, s57
    s_waitcnt vmcnt(5) lgkmcnt(4)
    v_mfma_f32_32x32x16_bf16 v[140:155], v[180:183], v[116:119], v[140:155]
    ds_read_b64_tr_b16 v[172:173], v12 offset:24576
    ds_read_b64_tr_b16 v[174:175], v12 offset:25600
    ds_read_b64_tr_b16 v[176:177], v13 offset:24576
    ds_read_b64_tr_b16 v[178:179], v13 offset:25600
    v_mfma_f32_32x32x16_bf16 v[156:171], v[184:187], v[116:119], v[156:171]
    s_waitcnt vmcnt(4) lgkmcnt(4)
    v_mfma_f32_32x32x16_bf16 v[140:155], v[188:191], v[120:123], v[140:155]
    ds_read_b64_tr_b16 v[180:181], v12 offset:26624
    ds_read_b64_tr_b16 v[182:183], v12 offset:27648
    ds_read_b64_tr_b16 v[184:185], v13 offset:26624
    ds_read_b64_tr_b16 v[186:187], v13 offset:27648
    v_mfma_f32_32x32x16_bf16 v[156:171], v[192:195], v[120:123], v[156:171]
    s_waitcnt vmcnt(3) lgkmcnt(4)
    v_mfma_f32_32x32x16_bf16 v[140:155], v[172:175], v[124:127], v[140:155]
    ds_read_b64_tr_b16 v[188:189], v12 offset:28672
    ds_read_b64_tr_b16 v[190:191], v12 offset:29696
    ds_read_b64_tr_b16 v[192:193], v13 offset:28672
    ds_read_b64_tr_b16 v[194:195], v13 offset:29696
    v_mfma_f32_32x32x16_bf16 v[156:171], v[176:179], v[124:127], v[156:171]
    s_barrier
    s_waitcnt vmcnt(2) lgkmcnt(4)
    v_mfma_f32_32x32x16_bf16 v[140:155], v[180:183], v[128:131], v[140:155]
    ds_read_b64_tr_b16 v[172:173], v12 offset:30720
    ds_read_b64_tr_b16 v[174:175], v12 offset:31744
    ds_read_b64_tr_b16 v[176:177], v13 offset:30720
    ds_read_b64_tr_b16 v[178:179], v13 offset:31744
    v_mfma_f32_32x32x16_bf16 v[156:171], v[184:187], v[128:131], v[156:171]
    s_waitcnt vmcnt(1) lgkmcnt(4)
    v_mfma_f32_32x32x16_bf16 v[140:155], v[188:191], v[132:135], v[140:155]
    v_mfma_f32_32x32x16_bf16 v[156:171], v[192:195], v[132:135], v[156:171]
    s_waitcnt vmcnt(0) lgkmcnt(0)
    v_mfma_f32_32x32x16_bf16 v[140:155], v[172:175], v[136:139], v[140:155]
    v_mfma_f32_32x32x16_bf16 v[156:171], v[176:179], v[136:139], v[156:171]
    s_nop 7
    s_nop 3
    ds_write_b128 v246, v[156:159] offset:0
    ds_write_b128 v246, v[160:163] offset:1024
    ds_write_b128 v246, v[164:167] offset:2048
    ds_write_b128 v246, v[168:171] offset:3072
    s_waitcnt lgkmcnt(0)
    s_barrier
    ds_read_b128 v[156:159], v247 offset:0
    ds_read_b128 v[160:163], v247 offset:1024
    ds_read_b128 v[164:167], v247 offset:2048
    ds_read_b128 v[168:171], v247 offset:3072
    s_waitcnt lgkmcnt(3)
    v_add_f32 v140, v140, v156
    v_add_f32 v141, v141, v157
    v_add_f32 v142, v142, v158
    v_add_f32 v143, v143, v159
    s_waitcnt lgkmcnt(2)
    v_add_f32 v144, v144, v160
    v_add_f32 v145, v145, v161
    v_add_f32 v146, v146, v162
    v_add_f32 v147, v147, v163
    s_waitcnt lgkmcnt(1)
    v_add_f32 v148, v148, v164
    v_add_f32 v149, v149, v165
    v_add_f32 v150, v150, v166
    v_add_f32 v151, v151, v167
    s_waitcnt lgkmcnt(0)
    v_add_f32 v152, v152, v168
    v_add_f32 v153, v153, v169
    v_add_f32 v154, v154, v170
    v_add_f32 v155, v155, v171
    v_cvt_pk_bf16_f32 v4, v140, v141
    v_cvt_pk_bf16_f32 v5, v142, v143
    v_cvt_pk_bf16_f32 v6, v144, v145
    v_cvt_pk_bf16_f32 v7, v146, v147
    v_cvt_pk_bf16_f32 v8, v148, v149
    v_cvt_pk_bf16_f32 v9, v150, v151
    v_cvt_pk_bf16_f32 v10, v152, v153
    v_cvt_pk_bf16_f32 v11, v154, v155
    v_mov_b32 v172, 0
    v_mov_b32 v173, 0
    buffer_store_dwordx4 v[4:7], v1, s[28:31], s72 offen sc1
    buffer_store_dwordx4 v[8:11], v1, s[28:31], s72 offen offset:1024 sc1
    v_dot2c_f32_bf16 v172, s66, v4
    v_dot2c_f32_bf16 v173, v4, v4
    v_dot2c_f32_bf16 v172, s66, v5
    v_dot2c_f32_bf16 v173, v5, v5
    v_dot2c_f32_bf16 v172, s66, v6
    v_dot2c_f32_bf16 v173, v6, v6
    v_dot2c_f32_bf16 v172, s66, v7
    v_dot2c_f32_bf16 v173, v7, v7
    v_dot2c_f32_bf16 v172, s66, v8
    v_dot2c_f32_bf16 v173, v8, v8
    v_dot2c_f32_bf16 v172, s66, v9
    v_dot2c_f32_bf16 v173, v9, v9
    v_dot2c_f32_bf16 v172, s66, v10
    v_dot2c_f32_bf16 v173, v10, v10
    v_dot2c_f32_bf16 v172, s66, v11
    v_dot2c_f32_bf16 v173, v11, v11
    s_nop 2
    v_permlane32_swap_b32 v172, v173
    v_add_f32 v172, v172, v173
    buffer_store_dword v172, v248, s[28:31], s78 offen sc1
    s_waitcnt vmcnt(0)
    v_mov_b32 v176, s53
    s_mov_b64 exec, 1
    s_cmp_eq_u32 s82, 0
    s_cbranch_scc1 L_st_16
    buffer_store_dword v176, v249, s[28:31], 0 offen offset:0
    s_branch L_st_16_d
L_st_16:
    buffer_store_dword v176, v249, s[28:31], 0 offen offset:0 sc1
L_st_16_d:
    s_mov_b64 exec, -1
    s_branch L_b12
.p2align 9
L_g1_post:
    s_waitcnt vmcnt(0) lgkmcnt(0)
    s_barrier
    v_cmp_eq_u32 vcc, s53, v182
    v_cmp_eq_u32 s[74:75], s83, v183
    s_nop 1
    s_and_b64 vcc, vcc, s[74:75]
    s_cmp_eq_u64 vcc, -1
    s_cselect_b32 s82, 1, 0
    v_max_f32 v184, v161, v155
    v_sub_f32 v185, v161, v184
    v_sub_f32 v186, v155, v184
    v_exp_f32 v185, v185
    v_exp_f32 v186, v186
    s_nop 0
    v_mul_f32 v187, v185, v160
    v_fma_f32 v187, v186, v60, v187
    v_rcp_f32 v187, v187
    s_nop 0
    v_mul_f32 v185, v185, v187
    v_mul_f32 v186, v186, v187
    v_mul_f32 v52, v52, v186
    v_mul_f32 v53, v53, v186
    v_mul_f32 v54, v54, v186
    v_mul_f32 v55, v55, v186
    v_mul_f32 v56, v56, v186
    v_mul_f32 v57, v57, v186
    v_mul_f32 v58, v58, v186
    v_mul_f32 v59, v59, v186
    v_fma_f32 v52, v164, v185, v52
    v_fma_f32 v53, v165, v185, v53
    v_fma_f32 v54, v166, v185, v54
    v_fma_f32 v55, v167, v185, v55
    v_fma_f32 v56, v168, v185, v56
    v_fma_f32 v57, v169, v185, v57
    v_fma_f32 v58, v170, v185, v58
    v_fma_f32 v59, v171, v185, v59
    v_cvt_pk_bf16_f32 v192, v52, v53
    v_cvt_pk_bf16_f32 v193, v54, v55
    v_cvt_pk_bf16_f32 v194, v56, v57
    v_cvt_pk_bf16_f32 v195, v58, v59
    s_lshl_b32 s72, s67, 15
    s_lshl_b32 s57, s50, 12
    s_lshl_b32 s58, s55, 11
    s_add_u32 s72, s72, s57
    s_add_u32 s72, s72, s58
    s_add_u32 s72, s72, 1048576
    buffer_store_dwordx4 v[192:195], v1, s[28:31], s72 offen offset:0 sc1
    v_max_f32 v184, v163, v156
    v_sub_f32 v185, v163, v184
    v_sub_f32 v186, v156, v184
    v_exp_f32 v185, v185
    v_exp_f32 v186, v186
    s_nop 0
    v_mul_f32 v187, v185, v162
    v_fma_f32 v187, v186, v76, v187
    v_rcp_f32 v187, v187
    s_nop 0
    v_mul_f32 v185, v185, v187
    v_mul_f32 v186, v186, v187
    v_mul_f32 v68, v68, v186
    v_mul_f32 v69, v69, v186
    v_mul_f32 v70, v70, v186
    v_mul_f32 v71, v71, v186
    v_mul_f32 v72, v72, v186
    v_mul_f32 v73, v73, v186
    v_mul_f32 v74, v74, v186
    v_mul_f32 v75, v75, v186
    v_fma_f32 v68, v172, v185, v68
    v_fma_f32 v69, v173, v185, v69
    v_fma_f32 v70, v174, v185, v70
    v_fma_f32 v71, v175, v185, v71
    v_fma_f32 v72, v176, v185, v72
    v_fma_f32 v73, v177, v185, v73
    v_fma_f32 v74, v178, v185, v74
    v_fma_f32 v75, v179, v185, v75
    v_cvt_pk_bf16_f32 v196, v68, v69
    v_cvt_pk_bf16_f32 v197, v70, v71
    v_cvt_pk_bf16_f32 v198, v72, v73
    v_cvt_pk_bf16_f32 v199, v74, v75
    buffer_store_dwordx4 v[196:199], v1, s[28:31], s72 offen offset:1024 sc1
    s_lshl_b32 s57, s50, 1
    s_add_u32 s57, s57, s55
    s_lshl_b32 s57, s57, 4
    s_lshl_b32 s59, s67, 8
    s_add_u32 s57, s57, s59
    s_add_u32 s57, s57, 139264
    v_mov_b32 v184, s57
    s_cmp_lt_u32 s52, 29
    s_cselect_b32 s77, 1, 0
    s_mul_i32 s62, s52, 3
    s_min_u32 s62, s62, 83
    s_lshl_b32 s73, s62, 5
    s_waitcnt vmcnt(0)
    v_mov_b32 v185, s53
    s_mov_b64 exec, 1
    s_cmp_eq_u32 s82, 0
    s_cbranch_scc1 L_st_17
    buffer_store_dword v185, v184, s[28:31], 0 offen offset:0
    s_branch L_st_17_d
L_st_17:
    buffer_store_dword v185, v184, s[28:31], 0 offen offset:0 sc1
L_st_17_d:
    s_mov_b64 exec, -1
    s_mov_b32 s36, s20
    s_mov_b32 s37, s21
    s_mov_b32 s38, 1409024
    s_mov_b32 s39, 0x20000
    s_mul_i32 s57, s76, 15
    s_add_u32 s58, s57, 56
    s_cmp_lt_u32 s76, 2
    s_cselect_b32 s57, s57, s58
    s_lshl_b32 s57, s57, 13
    s_lshl_b32 s58, s50, 7
    s_add_u32 s57, s57, s58
    buffer_load_dwordx4 v[64:67], v2, s[36:39], s57 offen
    s_add_u32 s57, s57, 8192
    buffer_load_dwordx4 v[68:71], v2, s[36:39], s57 offen
    s_add_u32 s57, s57, 8192
    buffer_load_dwordx4 v[72:75], v2, s[36:39], s57 offen
    s_add_u32 s57, s57, 8192
    buffer_load_dwordx4 v[76:79], v2, s[36:39], s57 offen
    s_add_u32 s57, s57, 8192
    buffer_load_dwordx4 v[80:83], v2, s[36:39], s57 offen
    s_add_u32 s57, s57, 8192
    buffer_load_dwordx4 v[84:87], v2, s[36:39], s57 offen
    s_add_u32 s57, s57, 8192
    s_waitcnt vmcnt(5)
    buffer_load_dwordx4 v[88:91], v2, s[36:39], s57 offen
    s_add_u32 s57, s57, 8192
    s_waitcnt vmcnt(5)
    buffer_load_dwordx4 v[92:95], v2, s[36:39], s57 offen
    s_add_u32 s57, s57, 8192
    s_waitcnt vmcnt(5)
    buffer_load_dwordx4 v[96:99], v2, s[36:39], s57 offen
    s_add_u32 s57, s57, 8192
    s_waitcnt vmcnt(5)
    buffer_load_dwordx4 v[100:103], v2, s[36:39], s57 offen
    s_add_u32 s57, s57, 8192
    s_waitcnt vmcnt(5)
    buffer_load_dwordx4 v[104:107], v2, s[36:39], s57 offen
    s_add_u32 s57, s57, 8192
    s_waitcnt vmcnt(5)
    buffer_load_dwordx4 v[108:111], v2, s[36:39], s57 offen
    s_add_u32 s57, s57, 8192
    s_waitcnt vmcnt(5)
    buffer_load_dwordx4 v[112:115], v2, s[36:39], s57 offen
    s_add_u32 s57, s57, 8192
    s_waitcnt vmcnt(5)
    buffer_load_dwordx4 v[116:119], v2, s[36:39], s57 offen
    s_add_u32 s57, s57, 8192
    s_waitcnt vmcnt(5)
    buffer_load_dwordx4 v[120:123], v2, s[36:39], s57 offen
    v_and_b32 v20, 15, v0
    v_lshrrev_b32 v12, 2, v20
    v_lshrrev_b32 v21, 5, v0
    v_lshl_add_u32 v12, v21, 2, v12
    v_mul_u32_u24 v12, 192, v12
    v_and_b32 v20, 3, v20
    v_lshl_add_u32 v12, v20, 3, v12
    v_bfe_u32 v20, v0, 4, 1
    v_mul_u32_u24 v20, 96, v20
    v_add_u32 v12, v12, v20
    v_add_u32 v12, 65536, v12
    s_mul_i32 s57, s76, 24576
    v_add_u32 v12, s57, v12
    v_and_b32 v13, 31, v0
    v_lshlrev_b32 v13, 4, v13
    s_lshl_b32 s57, s76, 2
    s_add_u32 s57, s57, 61440
    v_add_u32 v13, s57, v13
    s_barrier
    s_barrier
    s_cmp_eq_u32 s77, 0
    s_cbranch_scc1 L_g1_nocs
    v_mov_b32 v16, 0
    v_mov_b32 v17, 0
    v_mov_b32 v18, 0
    ds_read_b64_tr_b16 v[24:25], v12 offset:0
    ds_read_b64_tr_b16 v[26:27], v12 offset:1536
    ds_read_b64_tr_b16 v[28:29], v12 offset:32
    ds_read_b64_tr_b16 v[30:31], v12 offset:1568
    ds_read_b64_tr_b16 v[32:33], v12 offset:64
    ds_read_b64_tr_b16 v[34:35], v12 offset:1600
    ds_read_b64_tr_b16 v[36:37], v12 offset:3072
    ds_read_b64_tr_b16 v[38:39], v12 offset:4608
    ds_read_b64_tr_b16 v[40:41], v12 offset:3104
    ds_read_b64_tr_b16 v[42:43], v12 offset:4640
    ds_read_b64_tr_b16 v[44:45], v12 offset:3136
    ds_read_b64_tr_b16 v[46:47], v12 offset:4672
    s_waitcnt lgkmcnt(6)
    v_dot2c_f32_bf16 v16, s66, v24
    v_dot2c_f32_bf16 v16, s66, v25
    v_dot2c_f32_bf16 v16, s66, v26
    v_dot2c_f32_bf16 v16, s66, v27
    v_dot2c_f32_bf16 v17, s66, v28
    v_dot2c_f32_bf16 v17, s66, v29
    v_dot2c_f32_bf16 v17, s66, v30
    v_dot2c_f32_bf16 v17, s66, v31
    v_dot2c_f32_bf16 v18, s66, v32
    v_dot2c_f32_bf16 v18, s66, v33
    v_dot2c_f32_bf16 v18, s66, v34
    v_dot2c_f32_bf16 v18, s66, v35
    ds_read_b64_tr_b16 v[48:49], v12 offset:6144
    ds_read_b64_tr_b16 v[50:51], v12 offset:7680
    ds_read_b64_tr_b16 v[52:53], v12 offset:6176
    ds_read_b64_tr_b16 v[54:55], v12 offset:7712
    ds_read_b64_tr_b16 v[56:57], v12 offset:6208
    ds_read_b64_tr_b16 v[58:59], v12 offset:7744
    s_waitcnt lgkmcnt(6)
    v_dot2c_f32_bf16 v16, s66, v36
    v_dot2c_f32_bf16 v16, s66, v37
    v_dot2c_f32_bf16 v16, s66, v38
    v_dot2c_f32_bf16 v16, s66, v39
    v_dot2c_f32_bf16 v17, s66, v40
    v_dot2c_f32_bf16 v17, s66, v41
    v_dot2c_f32_bf16 v17, s66, v42
    v_dot2c_f32_bf16 v17, s66, v43
    v_dot2c_f32_bf16 v18, s66, v44
    v_dot2c_f32_bf16 v18, s66, v45
    v_dot2c_f32_bf16 v18, s66, v46
    v_dot2c_f32_bf16 v18, s66, v47
    ds_read_b64_tr_b16 v[24:25], v12 offset:9216
    ds_read_b64_tr_b16 v[26:27], v12 offset:10752
    ds_read_b64_tr_b16 v[28:29], v12 offset:9248
    ds_read_b64_tr_b16 v[30:31], v12 offset:10784
    ds_read_b64_tr_b16 v[32:33], v12 offset:9280
    ds_read_b64_tr_b16 v[34:35], v12 offset:10816
    s_waitcnt lgkmcnt(6)
    v_dot2c_f32_bf16 v16, s66, v48
    v_dot2c_f32_bf16 v16, s66, v49
    v_dot2c_f32_bf16 v16, s66, v50
    v_dot2c_f32_bf16 v16, s66, v51
    v_dot2c_f32_bf16 v17, s66, v52
    v_dot2c_f32_bf16 v17, s66, v53
    v_dot2c_f32_bf16 v17, s66, v54
    v_dot2c_f32_bf16 v17, s66, v55
    v_dot2c_f32_bf16 v18, s66, v56
    v_dot2c_f32_bf16 v18, s66, v57
    v_dot2c_f32_bf16 v18, s66, v58
    v_dot2c_f32_bf16 v18, s66, v59
    ds_read_b64_tr_b16 v[36:37], v12 offset:12288
    ds_read_b64_tr_b16 v[38:39], v12 offset:13824
    ds_read_b64_tr_b16 v[40:41], v12 offset:12320
    ds_read_b64_tr_b16 v[42:43], v12 offset:13856
    ds_read_b64_tr_b16 v[44:45], v12 offset:12352
    ds_read_b64_tr_b16 v[46:47], v12 offset:13888
    s_waitcnt lgkmcnt(6)
    v_dot2c_f32_bf16 v16, s66, v24
    v_dot2c_f32_bf16 v16, s66, v25
    v_dot2c_f32_bf16 v16, s66, v26
    v_dot2c_f32_bf16 v16, s66, v27
    v_dot2c_f32_bf16 v17, s66, v28
    v_dot2c_f32_bf16 v17, s66, v29
    v_dot2c_f32_bf16 v17, s66, v30
    v_dot2c_f32_bf16 v17, s66, v31
    v_dot2c_f32_bf16 v18, s66, v32
    v_dot2c_f32_bf16 v18, s66, v33
    v_dot2c_f32_bf16 v18, s66, v34
    v_dot2c_f32_bf16 v18, s66, v35
    ds_read_b64_tr_b16 v[48:49], v12 offset:15360
    ds_read_b64_tr_b16 v[50:51], v12 offset:16896
    ds_read_b64_tr_b16 v[52:53], v12 offset:15392
    ds_read_b64_tr_b16 v[54:55], v12 offset:16928
    ds_read_b64_tr_b16 v[56:57], v12 offset:15424
    ds_read_b64_tr_b16 v[58:59], v12 offset:16960
    s_waitcnt lgkmcnt(6)
    v_dot2c_f32_bf16 v16, s66, v36
    v_dot2c_f32_bf16 v16, s66, v37
    v_dot2c_f32_bf16 v16, s66, v38
    v_dot2c_f32_bf16 v16, s66, v39
    v_dot2c_f32_bf16 v17, s66, v40
    v_dot2c_f32_bf16 v17, s66, v41
    v_dot2c_f32_bf16 v17, s66, v42
    v_dot2c_f32_bf16 v17, s66, v43
    v_dot2c_f32_bf16 v18, s66, v44
    v_dot2c_f32_bf16 v18, s66, v45
    v_dot2c_f32_bf16 v18, s66, v46
    v_dot2c_f32_bf16 v18, s66, v47
    ds_read_b64_tr_b16 v[24:25], v12 offset:18432
    ds_read_b64_tr_b16 v[26:27], v12 offset:19968
    ds_read_b64_tr_b16 v[28:29], v12 offset:18464
    ds_read_b64_tr_b16 v[30:31], v12 offset:20000
    ds_read_b64_tr_b16 v[32:33], v12 offset:18496
    ds_read_b64_tr_b16 v[34:35], v12 offset:20032
    s_waitcnt lgkmcnt(6)
    v_dot2c_f32_bf16 v16, s66, v48
    v_dot2c_f32_bf16 v16, s66, v49
    v_dot2c_f32_bf16 v16, s66, v50
    v_dot2c_f32_bf16 v16, s66, v51
    v_dot2c_f32_bf16 v17, s66, v52
    v_dot2c_f32_bf16 v17, s66, v53
    v_dot2c_f32_bf16 v17, s66, v54
    v_dot2c_f32_bf16 v17, s66, v55
    v_dot2c_f32_bf16 v18, s66, v56
    v_dot2c_f32_bf16 v18, s66, v57
    v_dot2c_f32_bf16 v18, s66, v58
    v_dot2c_f32_bf16 v18, s66, v59
    ds_read_b64_tr_b16 v[36:37], v12 offset:21504
    ds_read_b64_tr_b16 v[38:39], v12 offset:23040
    ds_read_b64_tr_b16 v[40:41], v12 offset:21536
    ds_read_b64_tr_b16 v[42:43], v12 offset:23072
    ds_read_b64_tr_b16 v[44:45], v12 offset:21568
    ds_read_b64_tr_b16 v[46:47], v12 offset:23104
    s_waitcnt lgkmcnt(6)
    v_dot2c_f32_bf16 v16, s66, v24
    v_dot2c_f32_bf16 v16, s66, v25
    v_dot2c_f32_bf16 v16, s66, v26
    v_dot2c_f32_bf16 v16, s66, v27
    v_dot2c_f32_bf16 v17, s66, v28
    v_dot2c_f32_bf16 v17, s66, v29
    v_dot2c_f32_bf16 v17, s66, v30
    v_dot2c_f32_bf16 v17, s66, v31
    v_dot2c_f32_bf16 v18, s66, v32
    v_dot2c_f32_bf16 v18, s66, v33
    v_dot2c_f32_bf16 v18, s66, v34
    v_dot2c_f32_bf16 v18, s66, v35
    s_waitcnt lgkmcnt(0)
    v_dot2c_f32_bf16 v16, s66, v36
    v_dot2c_f32_bf16 v16, s66, v37
    v_dot2c_f32_bf16 v16, s66, v38
    v_dot2c_f32_bf16 v16, s66, v39
    v_dot2c_f32_bf16 v17, s66, v40
    v_dot2c_f32_bf16 v17, s66, v41
    v_dot2c_f32_bf16 v17, s66, v42
    v_dot2c_f32_bf16 v17, s66, v43
    v_dot2c_f32_bf16 v18, s66, v44
    v_dot2c_f32_bf16 v18, s66, v45
    v_dot2c_f32_bf16 v18, s66, v46
    v_dot2c_f32_bf16 v18, s66, v47
    s_nop 1
    v_mov_b32 v20, v16
    v_mov_b32 v21, v17
    v_mov_b32 v22, v18
    s_nop 1
    v_permlane32_swap_b32 v16, v20
    v_permlane32_swap_b32 v17, v21
    v_permlane32_swap_b32 v18, v22
    v_add_f32 v16, v16, v20
    v_add_f32 v17, v17, v21
    v_add_f32 v18, v18, v22
    ds_write_b32 v13, v16 offset:0
    ds_write_b32 v13, v17 offset:512
    ds_write_b32 v13, v18 offset:1024
    s_waitcnt lgkmcnt(0)
L_g1_nocs:
    s_lshl_b32 s57, s76, 2
    s_add_u32 s57, s57, 63488
    v_mov_b32 v14, s57
    v_mov_b32 v15, 0
    ds_write_b32 v14, v15
    s_waitcnt vmcnt(0) lgkmcnt(0)
    s_branch L_b12
.p2align 9
L_b12:
    s_barrier
    s_mov_b32 s36, s20
    s_mov_b32 s37, s21
    s_mov_b32 s38, 1409024
    s_mov_b32 s39, 0x20000
    s_lshl_b32 s57, s51, 3
    s_add_u32 s67, s57, s48
    s_mul_i32 s57, s76, 15360
    v_add_u32 v12, s57, v1
    s_cmp_eq_u32 s77, 0
    s_cbranch_scc0 L_d_go
    s_cmp_eq_u32 s56, 1
    s_cbranch_scc0 L_d_p1s
    ds_write_b128 v12, v[64:67] offset:0
    ds_write_b128 v12, v[68:71] offset:1024
    ds_write_b128 v12, v[72:75] offset:2048
    ds_write_b128 v12, v[76:79] offset:3072
    ds_write_b128 v12, v[80:83] offset:4096
    ds_write_b128 v12, v[84:87] offset:5120
    ds_write_b128 v12, v[88:91] offset:6144
    ds_write_b128 v12, v[92:95] offset:7168
    ds_write_b128 v12, v[96:99] offset:8192
    ds_write_b128 v12, v[100:103] offset:9216
    ds_write_b128 v12, v[104:107] offset:10240
    ds_write_b128 v12, v[108:111] offset:11264
    ds_write_b128 v12, v[112:115] offset:12288
    ds_write_b128 v12, v[116:119] offset:13312
    ds_write_b128 v12, v[120:123] offset:14336
L_d_p1s:
    s_waitcnt lgkmcnt(0)
    s_branch L_d_tile
L_d_go:
    v_and_b32 v13, 15, v0
    v_lshlrev_b32 v13, 4, v13
    s_lshl_b32 s57, s67, 8
    s_add_u32 s57, s57, 155648
    v_add_u32 v13, s57, v13
    s_cmp_eq_u32 s56, 0
    s_cselect_b32 s57, 2, 1
    s_cbranch_scc1 L_d_pr0
    s_setprio 1
    s_branch L_d_pr1
L_d_pr0:
    s_setprio 2
L_d_pr1:
    s_mov_b32 s70, 400000
    buffer_load_dword v14, v13, s[28:31], 0 offen offset:0 sc1
    s_cmp_eq_u32 s56, 1
    s_cbranch_scc0 L_d_p1a
    ds_write_b128 v12, v[64:67] offset:0
    ds_write_b128 v12, v[68:71] offset:1024
    ds_write_b128 v12, v[72:75] offset:2048
    ds_write_b128 v12, v[76:79] offset:3072
    ds_write_b128 v12, v[80:83] offset:4096
    ds_write_b128 v12, v[84:87] offset:5120
    ds_write_b128 v12, v[88:91] offset:6144
    ds_write_b128 v12, v[92:95] offset:7168
    ds_write_b128 v12, v[96:99] offset:8192
    ds_write_b128 v12, v[100:103] offset:9216
    ds_write_b128 v12, v[104:107] offset:10240
    ds_write_b128 v12, v[108:111] offset:11264
    ds_write_b128 v12, v[112:115] offset:12288
    ds_write_b128 v12, v[116:119] offset:13312
    ds_write_b128 v12, v[120:123] offset:14336
L_d_p1a:
L_fh_18:
    s_waitcnt vmcnt(0)
    v_cmp_ne_u32 vcc, s53, v14
    s_cbranch_vccz L_fh_18_x
    s_sub_u32 s70, s70, 1
    s_cbranch_scc1 L_fh_18_x
    buffer_load_dword v14, v13, s[28:31], 0 offen offset:0 sc1
    s_branch L_fh_18
L_fh_18_x:
    s_lshl_b32 s72, s67, 15
    s_add_u32 s72, s72, 3145728
    s_waitcnt lgkmcnt(0)
    buffer_load_dwordx4 v[16:19], v1, s[28:31], s72 offen offset:0 sc1
    buffer_load_dwordx4 v[20:23], v1, s[28:31], s72 offen offset:1024 sc1
    buffer_load_dwordx4 v[24:27], v1, s[28:31], s72 offen offset:2048 sc1
    s_lshl_b32 s57, s76, 2
    s_add_u32 s57, s57, 63488
    v_mov_b32 v13, s57
    s_cmp_eq_u32 s56, 0
    s_cbranch_scc1 L_d_nostag
    s_mov_b32 s70, 400000
L_dstag_19:
    ds_read_b32 v14, v13
    s_sub_u32 s70, s70, 1
    s_cbranch_scc1 L_dstag_19_x
    s_waitcnt lgkmcnt(0)
    v_readfirstlane_b32 s63, v14
    s_cmp_ge_u32 s63, 1
    s_cbranch_scc0 L_dstag_19
L_dstag_19_x:
    s_waitcnt lgkmcnt(0)
L_d_nostag:
    buffer_load_dwordx4 v[28:31], v1, s[28:31], s72 offen offset:3072 sc1
    s_add_u32 s72, s72, 4096
    buffer_load_dwordx4 v[32:35], v1, s[28:31], s72 offen offset:0 sc1
    buffer_load_dwordx4 v[36:39], v1, s[28:31], s72 offen offset:1024 sc1
    buffer_load_dwordx4 v[40:43], v1, s[28:31], s72 offen offset:2048 sc1
    buffer_load_dwordx4 v[44:47], v1, s[28:31], s72 offen offset:3072 sc1
    s_add_u32 s72, s72, 4096
    buffer_load_dwordx4 v[48:51], v1, s[28:31], s72 offen offset:0 sc1
    buffer_load_dwordx4 v[52:55], v1, s[28:31], s72 offen offset:1024 sc1
    v_and_b32 v216, 15, v0
    v_lshrrev_b32 v12, 2, v216
    v_lshrrev_b32 v217, 5, v0
    v_lshl_add_u32 v12, v217, 2, v12
    v_mul_u32_u24 v12, 192, v12
    v_and_b32 v216, 3, v216
    v_lshl_add_u32 v12, v216, 3, v12
    v_bfe_u32 v216, v0, 4, 1
    v_mul_u32_u24 v216, 96, v216
    v_add_u32 v12, v12, v216
    v_add_u32 v12, 65536, v12
    v_add_u32 v15, 49152, v12
    s_mov_b32 s78, 0xc0135761
    s_mov_b32 s80, 0xbdd2d3e8
    s_mul_i32 s3, s67, 88064
    s_lshl_b32 s57, s73, 5
    s_add_u32 s3, s3, s57
    s_add_u32 s3, s3, 5242880
    v_mov_b32 v218, s78
    ds_read_b64_tr_b16 v[192:193], v12 offset:0
    ds_read_b64_tr_b16 v[194:195], v12 offset:1536
    ds_read_b64_tr_b16 v[196:197], v12 offset:32
    ds_read_b64_tr_b16 v[198:199], v12 offset:1568
    ds_read_b64_tr_b16 v[200:201], v12 offset:64
    ds_read_b64_tr_b16 v[202:203], v12 offset:1600
    ds_read_b64_tr_b16 v[204:205], v12 offset:3072
    ds_read_b64_tr_b16 v[206:207], v12 offset:4608
    s_waitcnt vmcnt(9) lgkmcnt(6)
    v_mfma_f32_32x32x16_bf16 v[144:159], v[192:195], v[16:19], 0
    ds_read_b64_tr_b16 v[208:209], v12 offset:3104
    ds_read_b64_tr_b16 v[210:211], v12 offset:4640
    buffer_load_dwordx4 v[56:59], v1, s[28:31], s72 offen offset:2048 sc1
    s_waitcnt lgkmcnt(6)
    v_mfma_f32_32x32x16_bf16 v[160:175], v[196:199], v[16:19], 0
    ds_read_b64_tr_b16 v[212:213], v12 offset:3136
    ds_read_b64_tr_b16 v[214:215], v12 offset:4672
    s_waitcnt lgkmcnt(6)
    v_mfma_f32_32x32x16_bf16 v[176:191], v[200:203], v[16:19], 0
    ds_read_b64_tr_b16 v[192:193], v12 offset:6144
    ds_read_b64_tr_b16 v[194:195], v12 offset:7680
    s_waitcnt vmcnt(9) lgkmcnt(6)
    v_mfma_f32_32x32x16_bf16 v[144:159], v[204:207], v[20:23], v[144:159]
    ds_read_b64_tr_b16 v[196:197], v12 offset:6176
    ds_read_b64_tr_b16 v[198:199], v12 offset:7712
    buffer_load_dwordx4 v[60:63], v1, s[28:31], s72 offen offset:3072 sc1
    s_waitcnt lgkmcnt(6)
    v_mfma_f32_32x32x16_bf16 v[160:175], v[208:211], v[20:23], v[160:175]
    ds_read_b64_tr_b16 v[200:201], v12 offset:6208
    ds_read_b64_tr_b16 v[202:203], v12 offset:7744
    s_waitcnt lgkmcnt(6)
    v_mfma_f32_32x32x16_bf16 v[176:191], v[212:215], v[20:23], v[176:191]
    ds_read_b64_tr_b16 v[204:205], v12 offset:9216
    ds_read_b64_tr_b16 v[206:207], v12 offset:10752
    s_waitcnt vmcnt(9) lgkmcnt(6)
    v_mfma_f32_32x32x16_bf16 v[144:159], v[192:195], v[24:27], v[144:159]
    ds_read_b64_tr_b16 v[208:209], v12 offset:9248
    ds_read_b64_tr_b16 v[210:211], v12 offset:10784
    s_add_u32 s72, s72, 4096
    buffer_load_dwordx4 v[64:67], v1, s[28:31], s72 offen offset:0 sc1
    s_waitcnt lgkmcnt(6)
    v_mfma_f32_32x32x16_bf16 v[160:175], v[196:199], v[24:27], v[160:175]
    ds_read_b64_tr_b16 v[212:213], v12 offset:9280
    ds_read_b64_tr_b16 v[214:215], v12 offset:10816
    s_waitcnt lgkmcnt(6)
    v_mfma_f32_32x32x16_bf16 v[176:191], v[200:203], v[24:27], v[176:191]
    ds_read_b64_tr_b16 v[192:193], v12 offset:12288
    ds_read_b64_tr_b16 v[194:195], v12 offset:13824
    s_waitcnt vmcnt(9) lgkmcnt(6)
    v_mfma_f32_32x32x16_bf16 v[144:159], v[204:207], v[28:31], v[144:159]
    ds_read_b64_tr_b16 v[196:197], v12 offset:12320
    ds_read_b64_tr_b16 v[198:199], v12 offset:13856
    buffer_load_dwordx4 v[68:71], v1, s[28:31], s72 offen offset:1024 sc1
    s_waitcnt lgkmcnt(6)
    v_mfma_f32_32x32x16_bf16 v[160:175], v[208:211], v[28:31], v[160:175]
    ds_read_b64_tr_b16 v[200:201], v12 offset:12352
    ds_read_b64_tr_b16 v[202:203], v12 offset:13888
    s_waitcnt lgkmcnt(6)
    v_mfma_f32_32x32x16_bf16 v[176:191], v[212:215], v[28:31], v[176:191]
    ds_read_b64_tr_b16 v[204:205], v12 offset:15360
    ds_read_b64_tr_b16 v[206:207], v12 offset:16896
    s_waitcnt vmcnt(9) lgkmcnt(6)
    v_mfma_f32_32x32x16_bf16 v[144:159], v[192:195], v[32:35], v[144:159]
    ds_read_b64_tr_b16 v[208:209], v12 offset:15392
    ds_read_b64_tr_b16 v[210:211], v12 offset:16928
    buffer_load_dwordx4 v[72:75], v1, s[28:31], s72 offen offset:2048 sc1
    s_waitcnt lgkmcnt(6)
    v_mfma_f32_32x32x16_bf16 v[160:175], v[196:199], v[32:35], v[160:175]
    ds_read_b64_tr_b16 v[212:213], v12 offset:15424
    ds_read_b64_tr_b16 v[214:215], v12 offset:16960
    s_waitcnt lgkmcnt(6)
    v_mfma_f32_32x32x16_bf16 v[176:191], v[200:203], v[32:35], v[176:191]
    ds_read_b64_tr_b16 v[192:193], v12 offset:18432
    ds_read_b64_tr_b16 v[194:195], v12 offset:19968
    s_waitcnt vmcnt(9) lgkmcnt(6)
    v_mfma_f32_32x32x16_bf16 v[144:159], v[204:207], v[36:39], v[144:159]
    ds_read_b64_tr_b16 v[196:197], v12 offset:18464
    ds_read_b64_tr_b16 v[198:199], v12 offset:20000
    buffer_load_dwordx4 v[76:79], v1, s[28:31], s72 offen offset:3072 sc1
    s_waitcnt lgkmcnt(6)
    v_mfma_f32_32x32x16_bf16 v[160:175], v[208:211], v[36:39], v[160:175]
    ds_read_b64_tr_b16 v[200:201], v12 offset:18496
    ds_read_b64_tr_b16 v[202:203], v12 offset:20032
    s_waitcnt lgkmcnt(6)
    v_mfma_f32_32x32x16_bf16 v[176:191], v[212:215], v[36:39], v[176:191]
    ds_read_b64_tr_b16 v[204:205], v12 offset:21504
    ds_read_b64_tr_b16 v[206:207], v12 offset:23040
    s_waitcnt vmcnt(9) lgkmcnt(6)
    v_mfma_f32_32x32x16_bf16 v[144:159], v[192:195], v[40:43], v[144:159]
    ds_read_b64_tr_b16 v[208:209], v12 offset:21536
    ds_read_b64_tr_b16 v[210:211], v12 offset:23072
    s_add_u32 s72, s72, 4096
    buffer_load_dwordx4 v[80:83], v1, s[28:31], s72 offen offset:0 sc1
    s_waitcnt lgkmcnt(6)
    v_mfma_f32_32x32x16_bf16 v[160:175], v[196:199], v[40:43], v[160:175]
    ds_read_b64_tr_b16 v[212:213], v12 offset:21568
    ds_read_b64_tr_b16 v[214:215], v12 offset:23104
    s_waitcnt lgkmcnt(6)
    v_mfma_f32_32x32x16_bf16 v[176:191], v[200:203], v[40:43], v[176:191]
    ds_read_b64_tr_b16 v[192:193], v12 offset:24576
    ds_read_b64_tr_b16 v[194:195], v12 offset:26112
    s_waitcnt vmcnt(9) lgkmcnt(6)
    v_mfma_f32_32x32x16_bf16 v[144:159], v[204:207], v[44:47], v[144:159]
    ds_read_b64_tr_b16 v[196:197], v12 offset:24608
    ds_read_b64_tr_b16 v[198:199], v12 offset:26144
    buffer_load_dwordx4 v[84:87], v1, s[28:31], s72 offen offset:1024 sc1
    s_waitcnt lgkmcnt(6)
    v_mfma_f32_32x32x16_bf16 v[160:175], v[208:211], v[44:47], v[160:175]
    ds_read_b64_tr_b16 v[200:201], v12 offset:24640
    ds_read_b64_tr_b16 v[202:203], v12 offset:26176
    s_waitcnt lgkmcnt(6)
    v_mfma_f32_32x32x16_bf16 v[176:191], v[212:215], v[44:47], v[176:191]
    ds_read_b64_tr_b16 v[204:205], v12 offset:27648
    ds_read_b64_tr_b16 v[206:207], v12 offset:29184
    s_waitcnt vmcnt(9) lgkmcnt(6)
    v_mfma_f32_32x32x16_bf16 v[144:159], v[192:195], v[48:51], v[144:159]
    ds_read_b64_tr_b16 v[208:209], v12 offset:27680
    ds_read_b64_tr_b16 v[210:211], v12 offset:29216
    buffer_load_dwordx4 v[88:91], v1, s[28:31], s72 offen offset:2048 sc1
    s_waitcnt lgkmcnt(6)
    v_mfma_f32_32x32x16_bf16 v[160:175], v[196:199], v[48:51], v[160:175]
    ds_read_b64_tr_b16 v[212:213], v12 offset:27712
    ds_read_b64_tr_b16 v[214:215], v12 offset:29248
    s_waitcnt lgkmcnt(6)
    v_mfma_f32_32x32x16_bf16 v[176:191], v[200:203], v[48:51], v[176:191]
    ds_read_b64_tr_b16 v[192:193], v12 offset:30720
    ds_read_b64_tr_b16 v[194:195], v12 offset:32256
    s_waitcnt vmcnt(9) lgkmcnt(6)
    v_mfma_f32_32x32x16_bf16 v[144:159], v[204:207], v[52:55], v[144:159]
    ds_read_b64_tr_b16 v[196:197], v12 offset:30752
    ds_read_b64_tr_b16 v[198:199], v12 offset:32288
    buffer_load_dwordx4 v[92:95], v1, s[28:31], s72 offen offset:3072 sc1
    s_waitcnt lgkmcnt(6)
    v_mfma_f32_32x32x16_bf16 v[160:175], v[208:211], v[52:55], v[160:175]
    ds_read_b64_tr_b16 v[200:201], v12 offset:30784
    ds_read_b64_tr_b16 v[202:203], v12 offset:32320
    s_waitcnt lgkmcnt(6)
    v_mfma_f32_32x32x16_bf16 v[176:191], v[212:215], v[52:55], v[176:191]
    ds_read_b64_tr_b16 v[204:205], v12 offset:33792
    ds_read_b64_tr_b16 v[206:207], v12 offset:35328
    s_waitcnt vmcnt(9) lgkmcnt(6)
    v_mfma_f32_32x32x16_bf16 v[144:159], v[192:195], v[56:59], v[144:159]
    ds_read_b64_tr_b16 v[208:209], v12 offset:33824
    ds_read_b64_tr_b16 v[210:211], v12 offset:35360
    s_add_u32 s72, s72, 4096
    buffer_load_dwordx4 v[96:99], v1, s[28:31], s72 offen offset:0 sc1
    s_waitcnt lgkmcnt(6)
    v_mfma_f32_32x32x16_bf16 v[160:175], v[196:199], v[56:59], v[160:175]
    ds_read_b64_tr_b16 v[212:213], v12 offset:33856
    ds_read_b64_tr_b16 v[214:215], v12 offset:35392
    s_lshl_b32 s60, s67, 12
    s_add_u32 s60, s60, 262144
    v_lshlrev_b32 v216, 2, v0
    buffer_load_dword v16, v216, s[28:31], s60 offen offset:0 sc1
    buffer_load_dword v17, v216, s[28:31], s60 offen offset:256 sc1
    buffer_load_dword v18, v216, s[28:31], s60 offen offset:512 sc1
    buffer_load_dword v19, v216, s[28:31], s60 offen offset:768 sc1
    s_waitcnt lgkmcnt(6)
    v_mfma_f32_32x32x16_bf16 v[176:191], v[200:203], v[56:59], v[176:191]
    ds_read_b64_tr_b16 v[192:193], v12 offset:36864
    ds_read_b64_tr_b16 v[194:195], v12 offset:38400
    buffer_load_dword v20, v216, s[28:31], s60 offen offset:1024 sc1
    buffer_load_dword v21, v216, s[28:31], s60 offen offset:1280 sc1
    buffer_load_dword v22, v216, s[28:31], s60 offen offset:1536 sc1
    buffer_load_dword v23, v216, s[28:31], s60 offen offset:1792 sc1
    s_waitcnt vmcnt(17) lgkmcnt(6)
    v_mfma_f32_32x32x16_bf16 v[144:159], v[204:207], v[60:63], v[144:159]
    ds_read_b64_tr_b16 v[196:197], v12 offset:36896
    ds_read_b64_tr_b16 v[198:199], v12 offset:38432
    buffer_load_dwordx4 v[100:103], v1, s[28:31], s72 offen offset:1024 sc1
    buffer_load_dword v24, v216, s[28:31], s60 offen offset:2048 sc1
    buffer_load_dword v25, v216, s[28:31], s60 offen offset:2304 sc1
    buffer_load_dword v26, v216, s[28:31], s60 offen offset:2560 sc1
    buffer_load_dword v27, v216, s[28:31], s60 offen offset:2816 sc1
    s_waitcnt lgkmcnt(6)
    v_mfma_f32_32x32x16_bf16 v[160:175], v[208:211], v[60:63], v[160:175]
    ds_read_b64_tr_b16 v[200:201], v12 offset:36928
    ds_read_b64_tr_b16 v[202:203], v12 offset:38464
    buffer_load_dword v28, v216, s[28:31], s60 offen offset:3072 sc1
    buffer_load_dword v29, v216, s[28:31], s60 offen offset:3328 sc1
    buffer_load_dword v30, v216, s[28:31], s60 offen offset:3584 sc1
    buffer_load_dword v31, v216, s[28:31], s60 offen offset:3840 sc1
    s_waitcnt lgkmcnt(6)
    v_mfma_f32_32x32x16_bf16 v[176:191], v[212:215], v[60:63], v[176:191]
    ds_read_b64_tr_b16 v[204:205], v12 offset:39936
    ds_read_b64_tr_b16 v[206:207], v12 offset:41472
    s_waitcnt vmcnt(25) lgkmcnt(6)
    v_mfma_f32_32x32x16_bf16 v[144:159], v[192:195], v[64:67], v[144:159]
    ds_read_b64_tr_b16 v[208:209], v12 offset:39968
    ds_read_b64_tr_b16 v[210:211], v12 offset:41504
    buffer_load_dwordx4 v[104:107], v1, s[28:31], s72 offen offset:2048 sc1
    s_waitcnt lgkmcnt(6)
    v_mfma_f32_32x32x16_bf16 v[160:175], v[196:199], v[64:67], v[160:175]
    ds_read_b64_tr_b16 v[212:213], v12 offset:40000
    ds_read_b64_tr_b16 v[214:215], v12 offset:41536
    s_waitcnt lgkmcnt(6)
    v_mfma_f32_32x32x16_bf16 v[176:191], v[200:203], v[64:67], v[176:191]
    ds_read_b64_tr_b16 v[192:193], v12 offset:43008
    ds_read_b64_tr_b16 v[194:195], v12 offset:44544
    s_waitcnt vmcnt(25) lgkmcnt(6)
    v_mfma_f32_32x32x16_bf16 v[144:159], v[204:207], v[68:71], v[144:159]
    ds_read_b64_tr_b16 v[196:197], v12 offset:43040
    ds_read_b64_tr_b16 v[198:199], v12 offset:44576
    buffer_load_dwordx4 v[108:111], v1, s[28:31], s72 offen offset:3072 sc1
    s_waitcnt lgkmcnt(6)
    v_mfma_f32_32x32x16_bf16 v[160:175], v[208:211], v[68:71], v[160:175]
    ds_read_b64_tr_b16 v[200:201], v12 offset:43072
    ds_read_b64_tr_b16 v[202:203], v12 offset:44608
    s_waitcnt lgkmcnt(6)
    v_mfma_f32_32x32x16_bf16 v[176:191], v[212:215], v[68:71], v[176:191]
    ds_read_b64_tr_b16 v[204:205], v12 offset:46080
    ds_read_b64_tr_b16 v[206:207], v12 offset:47616
    s_waitcnt vmcnt(25) lgkmcnt(6)
    v_mfma_f32_32x32x16_bf16 v[144:159], v[192:195], v[72:75], v[144:159]
    ds_read_b64_tr_b16 v[208:209], v12 offset:46112
    ds_read_b64_tr_b16 v[210:211], v12 offset:47648
    s_add_u32 s72, s72, 4096
    buffer_load_dwordx4 v[112:115], v1, s[28:31], s72 offen offset:0 sc1
    s_waitcnt lgkmcnt(6)
    v_mfma_f32_32x32x16_bf16 v[160:175], v[196:199], v[72:75], v[160:175]
    ds_read_b64_tr_b16 v[212:213], v12 offset:46144
    ds_read_b64_tr_b16 v[214:215], v12 offset:47680
    s_waitcnt lgkmcnt(6)
    v_mfma_f32_32x32x16_bf16 v[176:191], v[200:203], v[72:75], v[176:191]
    ds_read_b64_tr_b16 v[192:193], v15 offset:0
    ds_read_b64_tr_b16 v[194:195], v15 offset:1536
    s_waitcnt vmcnt(25) lgkmcnt(6)
    v_mfma_f32_32x32x16_bf16 v[144:159], v[204:207], v[76:79], v[144:159]
    ds_read_b64_tr_b16 v[196:197], v15 offset:32
    ds_read_b64_tr_b16 v[198:199], v15 offset:1568
    buffer_load_dwordx4 v[116:119], v1, s[28:31], s72 offen offset:1024 sc1
    s_waitcnt lgkmcnt(6)
    v_mfma_f32_32x32x16_bf16 v[160:175], v[208:211], v[76:79], v[160:175]
    ds_read_b64_tr_b16 v[200:201], v15 offset:64
    ds_read_b64_tr_b16 v[202:203], v15 offset:1600
    s_waitcnt lgkmcnt(6)
    v_mfma_f32_32x32x16_bf16 v[176:191], v[212:215], v[76:79], v[176:191]
    ds_read_b64_tr_b16 v[204:205], v15 offset:3072
    ds_read_b64_tr_b16 v[206:207], v15 offset:4608
    s_waitcnt vmcnt(25) lgkmcnt(6)
    v_mfma_f32_32x32x16_bf16 v[144:159], v[192:195], v[80:83], v[144:159]
    ds_read_b64_tr_b16 v[208:209], v15 offset:3104
    ds_read_b64_tr_b16 v[210:211], v15 offset:4640
    buffer_load_dwordx4 v[120:123], v1, s[28:31], s72 offen offset:2048 sc1
    s_waitcnt lgkmcnt(6)
    v_mfma_f32_32x32x16_bf16 v[160:175], v[196:199], v[80:83], v[160:175]
    ds_read_b64_tr_b16 v[212:213], v15 offset:3136
    ds_read_b64_tr_b16 v[214:215], v15 offset:4672
    s_waitcnt lgkmcnt(6)
    v_mfma_f32_32x32x16_bf16 v[176:191], v[200:203], v[80:83], v[176:191]
    ds_read_b64_tr_b16 v[192:193], v15 offset:6144
    ds_read_b64_tr_b16 v[194:195], v15 offset:7680
    s_waitcnt vmcnt(25) lgkmcnt(6)
    v_mfma_f32_32x32x16_bf16 v[144:159], v[204:207], v[84:87], v[144:159]
    ds_read_b64_tr_b16 v[196:197], v15 offset:6176
    ds_read_b64_tr_b16 v[198:199], v15 offset:7712
    buffer_load_dwordx4 v[124:127], v1, s[28:31], s72 offen offset:3072 sc1
    s_waitcnt lgkmcnt(6)
    v_mfma_f32_32x32x16_bf16 v[160:175], v[208:211], v[84:87], v[160:175]
    ds_read_b64_tr_b16 v[200:201], v15 offset:6208
    ds_read_b64_tr_b16 v[202:203], v15 offset:7744
    s_waitcnt lgkmcnt(6)
    v_mfma_f32_32x32x16_bf16 v[176:191], v[212:215], v[84:87], v[176:191]
    ds_read_b64_tr_b16 v[204:205], v15 offset:9216
    ds_read_b64_tr_b16 v[206:207], v15 offset:10752
    s_waitcnt vmcnt(25) lgkmcnt(6)
    v_mfma_f32_32x32x16_bf16 v[144:159], v[192:195], v[88:91], v[144:159]
    ds_read_b64_tr_b16 v[208:209], v15 offset:9248
    ds_read_b64_tr_b16 v[210:211], v15 offset:10784
    s_add_u32 s72, s72, 4096
    buffer_load_dwordx4 v[128:131], v1, s[28:31], s72 offen offset:0 sc1
    s_waitcnt lgkmcnt(6)
    v_mfma_f32_32x32x16_bf16 v[160:175], v[196:199], v[88:91], v[160:175]
    ds_read_b64_tr_b16 v[212:213], v15 offset:9280
    ds_read_b64_tr_b16 v[214:215], v15 offset:10816
    s_waitcnt lgkmcnt(6)
    v_mfma_f32_32x32x16_bf16 v[176:191], v[200:203], v[88:91], v[176:191]
    ds_read_b64_tr_b16 v[192:193], v15 offset:12288
    ds_read_b64_tr_b16 v[194:195], v15 offset:13824
    s_waitcnt vmcnt(25) lgkmcnt(6)
    v_mfma_f32_32x32x16_bf16 v[144:159], v[204:207], v[92:95], v[144:159]
    ds_read_b64_tr_b16 v[196:197], v15 offset:12320
    ds_read_b64_tr_b16 v[198:199], v15 offset:13856
    buffer_load_dwordx4 v[132:135], v1, s[28:31], s72 offen offset:1024 sc1
    v_mov_b32 v14, 1
    ds_write_b32 v13, v14
    s_waitcnt lgkmcnt(7)
    v_mfma_f32_32x32x16_bf16 v[160:175], v[208:211], v[92:95], v[160:175]
    ds_read_b64_tr_b16 v[200:201], v15 offset:12352
    ds_read_b64_tr_b16 v[202:203], v15 offset:13888
    s_waitcnt lgkmcnt(7)
    v_mfma_f32_32x32x16_bf16 v[176:191], v[212:215], v[92:95], v[176:191]
    ds_read_b64_tr_b16 v[204:205], v15 offset:15360
    ds_read_b64_tr_b16 v[206:207], v15 offset:16896
    s_waitcnt vmcnt(25) lgkmcnt(7)
    v_mfma_f32_32x32x16_bf16 v[144:159], v[192:195], v[96:99], v[144:159]
    ds_read_b64_tr_b16 v[208:209], v15 offset:15392
    ds_read_b64_tr_b16 v[210:211], v15 offset:16928
    buffer_load_dwordx4 v[136:139], v1, s[28:31], s72 offen offset:2048 sc1
    s_waitcnt lgkmcnt(7)
    v_mfma_f32_32x32x16_bf16 v[160:175], v[196:199], v[96:99], v[160:175]
    ds_read_b64_tr_b16 v[212:213], v15 offset:15424
    ds_read_b64_tr_b16 v[214:215], v15 offset:16960
    s_waitcnt lgkmcnt(6)
    v_mfma_f32_32x32x16_bf16 v[176:191], v[200:203], v[96:99], v[176:191]
    ds_read_b64_tr_b16 v[192:193], v15 offset:18432
    ds_read_b64_tr_b16 v[194:195], v15 offset:19968
    s_waitcnt vmcnt(17) lgkmcnt(6)
    v_mfma_f32_32x32x16_bf16 v[144:159], v[204:207], v[100:103], v[144:159]
    ds_read_b64_tr_b16 v[196:197], v15 offset:18464
    ds_read_b64_tr_b16 v[198:199], v15 offset:20000
    buffer_load_dwordx4 v[140:143], v1, s[28:31], s72 offen offset:3072 sc1
    s_waitcnt lgkmcnt(6)
    v_mfma_f32_32x32x16_bf16 v[160:175], v[208:211], v[100:103], v[160:175]
    ds_read_b64_tr_b16 v[200:201], v15 offset:18496
    ds_read_b64_tr_b16 v[202:203], v15 offset:20032
    s_waitcnt lgkmcnt(6)
    v_mfma_f32_32x32x16_bf16 v[176:191], v[212:215], v[100:103], v[176:191]
    ds_read_b64_tr_b16 v[204:205], v15 offset:21504
    ds_read_b64_tr_b16 v[206:207], v15 offset:23040
    s_waitcnt vmcnt(9) lgkmcnt(6)
    v_mfma_f32_32x32x16_bf16 v[144:159], v[192:195], v[104:107], v[144:159]
    ds_read_b64_tr_b16 v[208:209], v15 offset:21536
    ds_read_b64_tr_b16 v[210:211], v15 offset:23072
    s_waitcnt lgkmcnt(6)
    v_mfma_f32_32x32x16_bf16 v[160:175], v[196:199], v[104:107], v[160:175]
    ds_read_b64_tr_b16 v[212:213], v15 offset:21568
    ds_read_b64_tr_b16 v[214:215], v15 offset:23104
    s_waitcnt lgkmcnt(6)
    v_mfma_f32_32x32x16_bf16 v[176:191], v[200:203], v[104:107], v[176:191]
    ds_read_b64_tr_b16 v[192:193], v15 offset:24576
    ds_read_b64_tr_b16 v[194:195], v15 offset:26112
    s_waitcnt vmcnt(8) lgkmcnt(6)
    v_mfma_f32_32x32x16_bf16 v[144:159], v[204:207], v[108:111], v[144:159]
    ds_read_b64_tr_b16 v[196:197], v15 offset:24608
    ds_read_b64_tr_b16 v[198:199], v15 offset:26144
    s_waitcnt lgkmcnt(6)
    v_mfma_f32_32x32x16_bf16 v[160:175], v[208:211], v[108:111], v[160:175]
    ds_read_b64_tr_b16 v[200:201], v15 offset:24640
    ds_read_b64_tr_b16 v[202:203], v15 offset:26176
    s_waitcnt lgkmcnt(6)
    v_mfma_f32_32x32x16_bf16 v[176:191], v[212:215], v[108:111], v[176:191]
    ds_read_b64_tr_b16 v[204:205], v15 offset:27648
    ds_read_b64_tr_b16 v[206:207], v15 offset:29184
    s_waitcnt vmcnt(7) lgkmcnt(6)
    v_mfma_f32_32x32x16_bf16 v[144:159], v[192:195], v[112:115], v[144:159]
    ds_read_b64_tr_b16 v[208:209], v15 offset:27680
    ds_read_b64_tr_b16 v[210:211], v15 offset:29216
    s_waitcnt lgkmcnt(6)
    v_mfma_f32_32x32x16_bf16 v[160:175], v[196:199], v[112:115], v[160:175]
    ds_read_b64_tr_b16 v[212:213], v15 offset:27712
    ds_read_b64_tr_b16 v[214:215], v15 offset:29248
    s_waitcnt lgkmcnt(6)
    v_mfma_f32_32x32x16_bf16 v[176:191], v[200:203], v[112:115], v[176:191]
    ds_read_b64_tr_b16 v[192:193], v15 offset:30720
    ds_read_b64_tr_b16 v[194:195], v15 offset:32256
    s_waitcnt vmcnt(6) lgkmcnt(6)
    v_mfma_f32_32x32x16_bf16 v[144:159], v[204:207], v[116:119], v[144:159]
    ds_read_b64_tr_b16 v[196:197], v15 offset:30752
    ds_read_b64_tr_b16 v[198:199], v15 offset:32288
    s_waitcnt lgkmcnt(6)
    v_mfma_f32_32x32x16_bf16 v[160:175], v[208:211], v[116:119], v[160:175]
    ds_read_b64_tr_b16 v[200:201], v15 offset:30784
    ds_read_b64_tr_b16 v[202:203], v15 offset:32320
    s_waitcnt lgkmcnt(6)
    v_mfma_f32_32x32x16_bf16 v[176:191], v[212:215], v[116:119], v[176:191]
    ds_read_b64_tr_b16 v[204:205], v15 offset:33792
    ds_read_b64_tr_b16 v[206:207], v15 offset:35328
    s_waitcnt vmcnt(5) lgkmcnt(6)
    v_mfma_f32_32x32x16_bf16 v[144:159], v[192:195], v[120:123], v[144:159]
    ds_read_b64_tr_b16 v[208:209], v15 offset:33824
    ds_read_b64_tr_b16 v[210:211], v15 offset:35360
    s_waitcnt lgkmcnt(6)
    v_mfma_f32_32x32x16_bf16 v[160:175], v[196:199], v[120:123], v[160:175]
    ds_read_b64_tr_b16 v[212:213], v15 offset:33856
    ds_read_b64_tr_b16 v[214:215], v15 offset:35392
    s_waitcnt lgkmcnt(6)
    v_mfma_f32_32x32x16_bf16 v[176:191], v[200:203], v[120:123], v[176:191]
    ds_read_b64_tr_b16 v[192:193], v15 offset:36864
    ds_read_b64_tr_b16 v[194:195], v15 offset:38400
    s_waitcnt vmcnt(4) lgkmcnt(6)
    v_mfma_f32_32x32x16_bf16 v[144:159], v[204:207], v[124:127], v[144:159]
    ds_read_b64_tr_b16 v[196:197], v15 offset:36896
    ds_read_b64_tr_b16 v[198:199], v15 offset:38432
    s_waitcnt lgkmcnt(6)
    v_mfma_f32_32x32x16_bf16 v[160:175], v[208:211], v[124:127], v[160:175]
    ds_read_b64_tr_b16 v[200:201], v15 offset:36928
    ds_read_b64_tr_b16 v[202:203], v15 offset:38464
    s_waitcnt lgkmcnt(6)
    v_mfma_f32_32x32x16_bf16 v[176:191], v[212:215], v[124:127], v[176:191]
    ds_read_b64_tr_b16 v[204:205], v15 offset:39936
    ds_read_b64_tr_b16 v[206:207], v15 offset:41472
    v_and_b32 v217, 31, v0
    v_lshlrev_b32 v217, 4, v217
    v_add_u32 v217, 61440, v217
    ds_read_b128 v[32:35], v217 offset:0
    ds_read_b128 v[36:39], v217 offset:512
    ds_read_b128 v[40:43], v217 offset:1024
    s_waitcnt vmcnt(3) lgkmcnt(9)
    v_mfma_f32_32x32x16_bf16 v[144:159], v[192:195], v[128:131], v[144:159]
    ds_read_b64_tr_b16 v[208:209], v15 offset:39968
    ds_read_b64_tr_b16 v[210:211], v15 offset:41504
    s_waitcnt lgkmcnt(9)
    v_mfma_f32_32x32x16_bf16 v[160:175], v[196:199], v[128:131], v[160:175]
    ds_read_b64_tr_b16 v[212:213], v15 offset:40000
    ds_read_b64_tr_b16 v[214:215], v15 offset:41536
    s_waitcnt lgkmcnt(9)
    v_mfma_f32_32x32x16_bf16 v[176:191], v[200:203], v[128:131], v[176:191]
    ds_read_b64_tr_b16 v[192:193], v15 offset:43008
    ds_read_b64_tr_b16 v[194:195], v15 offset:44544
    s_waitcnt vmcnt(2) lgkmcnt(9)
    v_mfma_f32_32x32x16_bf16 v[144:159], v[204:207], v[132:135], v[144:159]
    ds_read_b64_tr_b16 v[196:197], v15 offset:43040
    ds_read_b64_tr_b16 v[198:199], v15 offset:44576
    s_waitcnt lgkmcnt(10)
    v_add_f32 v32, v32, v33
    v_add_f32 v34, v34, v35
    v_add_f32 v32, v32, v34
    v_cvt_pk_bf16_f32 v52, v32, v32
    v_mov_b32 v54, 0
    v_and_b32 v33, 0xffff0000, v52
    v_mov_b32 v55, 0
    v_sub_f32 v33, v32, v33
    v_cvt_pk_bf16_f32 v53, v33, v33
    s_waitcnt lgkmcnt(6)
    v_mfma_f32_32x32x16_bf16 v[160:175], v[208:211], v[132:135], v[160:175]
    ds_read_b64_tr_b16 v[200:201], v15 offset:43072
    ds_read_b64_tr_b16 v[202:203], v15 offset:44608
    s_waitcnt lgkmcnt(11)
    v_add_f32 v36, v36, v37
    v_add_f32 v38, v38, v39
    v_add_f32 v36, v36, v38
    v_cvt_pk_bf16_f32 v56, v36, v36
    v_mov_b32 v58, 0
    v_and_b32 v37, 0xffff0000, v56
    v_mov_b32 v59, 0
    v_sub_f32 v37, v36, v37
    v_cvt_pk_bf16_f32 v57, v37, v37
    s_waitcnt lgkmcnt(6)
    v_mfma_f32_32x32x16_bf16 v[176:191], v[212:215], v[132:135], v[176:191]
    ds_read_b64_tr_b16 v[204:205], v15 offset:46080
    ds_read_b64_tr_b16 v[206:207], v15 offset:47616
    s_waitcnt lgkmcnt(12)
    v_add_f32 v40, v40, v41
    v_add_f32 v42, v42, v43
    v_add_f32 v40, v40, v42
    v_cvt_pk_bf16_f32 v60, v40, v40
    v_mov_b32 v62, 0
    v_and_b32 v41, 0xffff0000, v60
    v_mov_b32 v63, 0
    v_sub_f32 v41, v40, v41
    v_cvt_pk_bf16_f32 v61, v41, v41
    s_waitcnt vmcnt(1) lgkmcnt(6)
    v_mfma_f32_32x32x16_bf16 v[144:159], v[192:195], v[136:139], v[144:159]
    ds_read_b64_tr_b16 v[208:209], v15 offset:46112
    ds_read_b64_tr_b16 v[210:211], v15 offset:47648
    s_waitcnt vmcnt(10)
    v_add_f32 v16, v16, v24
    v_add_f32 v17, v17, v25
    v_add_f32 v18, v18, v26
    v_add_f32 v19, v19, v27
    v_add_f32 v20, v20, v28
    v_add_f32 v21, v21, v29
    v_add_f32 v22, v22, v30
    v_add_f32 v23, v23, v31
    v_add_f32 v16, v16, v20
    v_add_f32 v17, v17, v21
    v_add_f32 v18, v18, v22
    v_add_f32 v19, v19, v23
    s_waitcnt lgkmcnt(6)
    v_mfma_f32_32x32x16_bf16 v[160:175], v[196:199], v[136:139], v[160:175]
    ds_read_b64_tr_b16 v[212:213], v15 offset:46144
    ds_read_b64_tr_b16 v[214:215], v15 offset:47680
    v_add_f32 v16, v16, v18
    v_add_f32 v17, v17, v19
    v_add_f32 v16, v16, v17
    s_nop 0
    v_mov_b32 v17, v16
    s_nop 1
    v_permlane32_swap_b32 v16, v17
    v_mul_f32 v224, 0xbb000000, v16
    v_mul_f32 v18, 0x3b000000, v17
    s_waitcnt lgkmcnt(6)
    v_mfma_f32_32x32x16_bf16 v[176:191], v[200:203], v[136:139], v[176:191]
    v_fma_f32 v18, -v224, v224, v18
    v_max_f32 v18, 0, v18
    v_add_f32 v18, 0x3727c5ac, v18
    v_rsq_f32 v226, v18
    v_mov_b32 v228, v18
    v_mul_f32 v218, s78, v226
    v_mul_f32 v227, s80, v226
    v_mul_f32 v227, v227, v226
    v_mul_f32 v227, v227, v226
    v_cvt_pk_bf16_f32 v19, v224, v224
    v_mov_b32 v222, 0
    v_and_b32 v19, 0xffff0000, v19
    v_mov_b32 v223, 0
    v_sub_f32 v19, v224, v19
    v_cvt_pk_bf16_f32 v19, v224, v19
    v_cndmask_b32 v220, v19, 0, s[64:65]
    v_cndmask_b32 v221, v19, 0, s[64:65]
    s_waitcnt vmcnt(0) lgkmcnt(4)
    v_mfma_f32_32x32x16_bf16 v[144:159], v[204:207], v[140:143], v[144:159]
    s_waitcnt lgkmcnt(2)
    v_mfma_f32_32x32x16_bf16 v[160:175], v[208:211], v[140:143], v[160:175]
    s_waitcnt lgkmcnt(0)
    v_mfma_f32_32x32x16_bf16 v[176:191], v[212:215], v[140:143], v[176:191]
    v_mfma_f32_32x32x16_bf16 v[144:159], v[52:55], v[220:223], v[144:159]
    v_mfma_f32_32x32x16_bf16 v[160:175], v[56:59], v[220:223], v[160:175]
    v_mfma_f32_32x32x16_bf16 v[176:191], v[60:63], v[220:223], v[176:191]
    s_nop 7
    s_nop 2
    v_mul_f32 v120, v144, v144
    v_mul_f32 v121, v145, v145
    v_mul_f32 v122, v146, v146
    v_mul_f32 v123, v147, v147
    v_mul_f32 v124, v148, v148
    v_mul_f32 v125, v149, v149
    v_mul_f32 v126, v150, v150
    v_mul_f32 v127, v151, v151
    v_fma_f32 v120, v120, v227, v218
    v_fma_f32 v121, v121, v227, v218
    v_fma_f32 v122, v122, v227, v218
    v_fma_f32 v123, v123, v227, v218
    v_fma_f32 v124, v124, v227, v218
    v_fma_f32 v125, v125, v227, v218
    v_fma_f32 v126, v126, v227, v218
    v_fma_f32 v127, v127, v227, v218
    v_mul_f32 v120, v120, v144
    v_mul_f32 v121, v121, v145
    v_mul_f32 v122, v122, v146
    v_mul_f32 v123, v123, v147
    v_mul_f32 v124, v124, v148
    v_mul_f32 v125, v125, v149
    v_mul_f32 v126, v126, v150
    v_mul_f32 v127, v127, v151
    v_exp_f32 v120, v120
    v_mul_f32 v144, v144, v152
    v_exp_f32 v121, v121
    v_mul_f32 v145, v145, v153
    v_exp_f32 v122, v122
    v_mul_f32 v146, v146, v154
    v_exp_f32 v123, v123
    v_mul_f32 v147, v147, v155
    v_exp_f32 v124, v124
    v_mul_f32 v148, v148, v156
    v_exp_f32 v125, v125
    v_mul_f32 v149, v149, v157
    v_exp_f32 v126, v126
    v_mul_f32 v150, v150, v158
    v_exp_f32 v127, v127
    v_mul_f32 v151, v151, v159
    v_fma_f32 v120, v120, v228, v228
    v_fma_f32 v121, v121, v228, v228
    v_fma_f32 v122, v122, v228, v228
    v_fma_f32 v123, v123, v228, v228
    v_fma_f32 v124, v124, v228, v228
    v_fma_f32 v125, v125, v228, v228
    v_fma_f32 v126, v126, v228, v228
    v_fma_f32 v127, v127, v228, v228
    v_rcp_f32 v120, v120
    v_rcp_f32 v121, v121
    v_rcp_f32 v122, v122
    v_rcp_f32 v123, v123
    v_rcp_f32 v124, v124
    v_rcp_f32 v125, v125
    v_rcp_f32 v126, v126
    v_rcp_f32 v127, v127
    s_nop 0
    v_mul_f32 v144, v144, v120
    v_mul_f32 v145, v145, v121
    v_mul_f32 v146, v146, v122
    v_mul_f32 v147, v147, v123
    v_mul_f32 v148, v148, v124
    v_mul_f32 v149, v149, v125
    v_mul_f32 v150, v150, v126
    v_mul_f32 v151, v151, v127
    v_cvt_pk_bf16_f32 v132, v144, v145
    v_cvt_pk_bf16_f32 v133, v146, v147
    v_cvt_pk_bf16_f32 v134, v148, v149
    v_cvt_pk_bf16_f32 v135, v150, v151
    buffer_store_dwordx4 v[132:135], v1, s[28:31], s3 offen offset:0 sc1
    v_mul_f32 v120, v160, v160
    v_mul_f32 v121, v161, v161
    v_mul_f32 v122, v162, v162
    v_mul_f32 v123, v163, v163
    v_mul_f32 v124, v164, v164
    v_mul_f32 v125, v165, v165
    v_mul_f32 v126, v166, v166
    v_mul_f32 v127, v167, v167
    v_fma_f32 v120, v120, v227, v218
    v_fma_f32 v121, v121, v227, v218
    v_fma_f32 v122, v122, v227, v218
    v_fma_f32 v123, v123, v227, v218
    v_fma_f32 v124, v124, v227, v218
    v_fma_f32 v125, v125, v227, v218
    v_fma_f32 v126, v126, v227, v218
    v_fma_f32 v127, v127, v227, v218
    v_mul_f32 v120, v120, v160
    v_mul_f32 v121, v121, v161
    v_mul_f32 v122, v122, v162
    v_mul_f32 v123, v123, v163
    v_mul_f32 v124, v124, v164
    v_mul_f32 v125, v125, v165
    v_mul_f32 v126, v126, v166
    v_mul_f32 v127, v127, v167
    v_exp_f32 v120, v120
    v_mul_f32 v160, v160, v168
    v_exp_f32 v121, v121
    v_mul_f32 v161, v161, v169
    v_exp_f32 v122, v122
    v_mul_f32 v162, v162, v170
    v_exp_f32 v123, v123
    v_mul_f32 v163, v163, v171
    v_exp_f32 v124, v124
    v_mul_f32 v164, v164, v172
    v_exp_f32 v125, v125
    v_mul_f32 v165, v165, v173
    v_exp_f32 v126, v126
    v_mul_f32 v166, v166, v174
    v_exp_f32 v127, v127
    v_mul_f32 v167, v167, v175
    v_fma_f32 v120, v120, v228, v228
    v_fma_f32 v121, v121, v228, v228
    v_fma_f32 v122, v122, v228, v228
    v_fma_f32 v123, v123, v228, v228
    v_fma_f32 v124, v124, v228, v228
    v_fma_f32 v125, v125, v228, v228
    v_fma_f32 v126, v126, v228, v228
    v_fma_f32 v127, v127, v228, v228
    v_rcp_f32 v120, v120
    v_rcp_f32 v121, v121
    v_rcp_f32 v122, v122
    v_rcp_f32 v123, v123
    v_rcp_f32 v124, v124
    v_rcp_f32 v125, v125
    v_rcp_f32 v126, v126
    v_rcp_f32 v127, v127
    s_nop 0
    v_mul_f32 v160, v160, v120
    v_mul_f32 v161, v161, v121
    v_mul_f32 v162, v162, v122
    v_mul_f32 v163, v163, v123
    v_mul_f32 v164, v164, v124
    v_mul_f32 v165, v165, v125
    v_mul_f32 v166, v166, v126
    v_mul_f32 v167, v167, v127
    v_cvt_pk_bf16_f32 v136, v160, v161
    v_cvt_pk_bf16_f32 v137, v162, v163
    v_cvt_pk_bf16_f32 v138, v164, v165
    v_cvt_pk_bf16_f32 v139, v166, v167
    buffer_store_dwordx4 v[136:139], v1, s[28:31], s3 offen offset:1024 sc1
    v_mul_f32 v120, v176, v176
    v_mul_f32 v121, v177, v177
    v_mul_f32 v122, v178, v178
    v_mul_f32 v123, v179, v179
    v_mul_f32 v124, v180, v180
    v_mul_f32 v125, v181, v181
    v_mul_f32 v126, v182, v182
    v_mul_f32 v127, v183, v183
    v_fma_f32 v120, v120, v227, v218
    v_fma_f32 v121, v121, v227, v218
    v_fma_f32 v122, v122, v227, v218
    v_fma_f32 v123, v123, v227, v218
    v_fma_f32 v124, v124, v227, v218
    v_fma_f32 v125, v125, v227, v218
    v_fma_f32 v126, v126, v227, v218
    v_fma_f32 v127, v127, v227, v218
    v_mul_f32 v120, v120, v176
    v_mul_f32 v121, v121, v177
    v_mul_f32 v122, v122, v178
    v_mul_f32 v123, v123, v179
    v_mul_f32 v124, v124, v180
    v_mul_f32 v125, v125, v181
    v_mul_f32 v126, v126, v182
    v_mul_f32 v127, v127, v183
    v_exp_f32 v120, v120
    v_mul_f32 v176, v176, v184
    v_exp_f32 v121, v121
    v_mul_f32 v177, v177, v185
    v_exp_f32 v122, v122
    v_mul_f32 v178, v178, v186
    v_exp_f32 v123, v123
    v_mul_f32 v179, v179, v187
    v_exp_f32 v124, v124
    v_mul_f32 v180, v180, v188
    v_exp_f32 v125, v125
    v_mul_f32 v181, v181, v189
    v_exp_f32 v126, v126
    v_mul_f32 v182, v182, v190
    v_exp_f32 v127, v127
    v_mul_f32 v183, v183, v191
    v_fma_f32 v120, v120, v228, v228
    v_fma_f32 v121, v121, v228, v228
    v_fma_f32 v122, v122, v228, v228
    v_fma_f32 v123, v123, v228, v228
    v_fma_f32 v124, v124, v228, v228
    v_fma_f32 v125, v125, v228, v228
    v_fma_f32 v126, v126, v228, v228
    v_fma_f32 v127, v127, v228, v228
    v_rcp_f32 v120, v120
    v_rcp_f32 v121, v121
    v_rcp_f32 v122, v122
    v_rcp_f32 v123, v123
    v_rcp_f32 v124, v124
    v_rcp_f32 v125, v125
    v_rcp_f32 v126, v126
    v_rcp_f32 v127, v127
    s_nop 0
    v_mul_f32 v176, v176, v120
    v_mul_f32 v177, v177, v121
    v_mul_f32 v178, v178, v122
    v_mul_f32 v179, v179, v123
    v_mul_f32 v180, v180, v124
    v_mul_f32 v181, v181, v125
    v_mul_f32 v182, v182, v126
    v_mul_f32 v183, v183, v127
    v_cvt_pk_bf16_f32 v128, v176, v177
    v_cvt_pk_bf16_f32 v129, v178, v179
    v_cvt_pk_bf16_f32 v130, v180, v181
    v_cvt_pk_bf16_f32 v131, v182, v183
    buffer_store_dwordx4 v[128:131], v1, s[28:31], s3 offen offset:2048 sc1
    s_lshl_b32 s57, s67, 9
    s_lshl_b32 s58, s52, 4
    s_add_u32 s57, s57, s58
    s_add_u32 s57, s57, 172032
    v_mov_b32 v120, s57
    s_waitcnt vmcnt(0)
    v_mov_b32 v121, s53
    s_mov_b64 exec, 1
    s_cmp_eq_u32 s82, 0
    s_cbranch_scc1 L_st_20
    buffer_store_dword v121, v120, s[28:31], 0 offen offset:0
    s_branch L_st_20_d
L_st_20:
    buffer_store_dword v121, v120, s[28:31], 0 offen offset:0 sc1
L_st_20_d:
    s_mov_b64 exec, -1
L_d_tile:
    s_setprio 0
    s_cmp_eq_u32 s56, 0
    s_cbranch_scc0 L_d_done
    s_mul_i32 s59, s76, 24
    s_cmp_lt_u32 s76, 2
    s_cselect_b32 s58, 30, 68
    s_add_u32 s59, s59, s58
    s_lshl_b32 s59, s59, 13
    s_lshl_b32 s58, s50, 7
    s_add_u32 s59, s59, s58
    buffer_load_dwordx4 v[16:19], v2, s[36:39], s59 offen
    s_add_u32 s59, s59, 8192
    buffer_load_dwordx4 v[20:23], v2, s[36:39], s59 offen
    s_add_u32 s59, s59, 8192
    buffer_load_dwordx4 v[24:27], v2, s[36:39], s59 offen
    s_add_u32 s59, s59, 8192
    buffer_load_dwordx4 v[28:31], v2, s[36:39], s59 offen
    s_add_u32 s59, s59, 8192
    buffer_load_dwordx4 v[32:35], v2, s[36:39], s59 offen
    s_add_u32 s59, s59, 8192
    buffer_load_dwordx4 v[36:39], v2, s[36:39], s59 offen
    s_add_u32 s59, s59, 8192
    buffer_load_dwordx4 v[40:43], v2, s[36:39], s59 offen
    s_add_u32 s59, s59, 8192
    buffer_load_dwordx4 v[44:47], v2, s[36:39], s59 offen
    s_add_u32 s59, s59, 8192
    s_waitcnt vmcnt(7)
    buffer_load_dwordx4 v[48:51], v2, s[36:39], s59 offen
    s_add_u32 s59, s59, 8192
    s_waitcnt vmcnt(7)
    buffer_load_dwordx4 v[52:55], v2, s[36:39], s59 offen
    s_add_u32 s59, s59, 8192
    s_waitcnt vmcnt(7)
    buffer_load_dwordx4 v[56:59], v2, s[36:39], s59 offen
    s_add_u32 s59, s59, 8192
    s_waitcnt vmcnt(7)
    buffer_load_dwordx4 v[60:63], v2, s[36:39], s59 offen
    s_add_u32 s59, s59, 8192
    s_waitcnt vmcnt(7)
    buffer_load_dwordx4 v[64:67], v2, s[36:39], s59 offen
    s_add_u32 s59, s59, 8192
    s_waitcnt vmcnt(7)
    buffer_load_dwordx4 v[68:71], v2, s[36:39], s59 offen
    s_add_u32 s59, s59, 8192
    s_waitcnt vmcnt(7)
    buffer_load_dwordx4 v[72:75], v2, s[36:39], s59 offen
    s_add_u32 s59, s59, 8192
    s_waitcnt vmcnt(7)
    buffer_load_dwordx4 v[76:79], v2, s[36:39], s59 offen
    s_add_u32 s59, s59, 8192
    s_waitcnt vmcnt(7)
    buffer_load_dwordx4 v[80:83], v2, s[36:39], s59 offen
    s_add_u32 s59, s59, 8192
    s_waitcnt vmcnt(7)
    buffer_load_dwordx4 v[84:87], v2, s[36:39], s59 offen
    s_add_u32 s59, s59, 8192
    s_waitcnt vmcnt(7)
    buffer_load_dwordx4 v[88:91], v2, s[36:39], s59 offen
    s_add_u32 s59, s59, 8192
    s_waitcnt vmcnt(7)
    buffer_load_dwordx4 v[92:95], v2, s[36:39], s59 offen
    s_add_u32 s59, s59, 8192
    s_waitcnt vmcnt(7)
    buffer_load_dwordx4 v[96:99], v2, s[36:39], s59 offen
    s_add_u32 s59, s59, 8192
    s_waitcnt vmcnt(7)
    buffer_load_dwordx4 v[100:103], v2, s[36:39], s59 offen
    s_add_u32 s59, s59, 8192
    s_waitcnt vmcnt(7)
    buffer_load_dwordx4 v[104:107], v2, s[36:39], s59 offen
    s_add_u32 s59, s59, 8192
    s_waitcnt vmcnt(7)
    buffer_load_dwordx4 v[108:111], v2, s[36:39], s59 offen
L_d_done:
    s_barrier
    s_mul_i32 s57, s76, 24576
    s_add_u32 s57, s57, 61440
    v_add_u32 v12, s57, v1
    s_cmp_eq_u32 s56, 1
    s_cbranch_scc1 L_g1_e
    s_lshl_b32 s67, s49, 1
    s_add_u32 s67, s67, s54
    v_and_b32 v244, 31, v0
    v_min_u32 v244, 28, v244
    v_lshlrev_b32 v244, 4, v244
    s_lshl_b32 s57, s67, 9
    s_add_u32 s57, s57, 172032
    v_add_u32 v244, s57, v244
    s_lshl_b32 s57, s76, 12
    s_add_u32 s57, s57, 8192
    v_add_u32 v246, s57, v1
    s_xor_b32 s57, s57, 4096
    v_add_u32 v247, s57, v1
    s_mov_b32 s32, s22
    s_mov_b32 s33, s23
    s_mov_b32 s34, 2097152
    s_mov_b32 s35, 0x20000
    s_mul_i32 s72, s67, 88064
    s_mul_i32 s57, s55, 44032
    s_add_u32 s72, s72, s57
    s_add_u32 s72, s72, 5242880
    s_lshl_b32 s73, s67, 15
    s_lshl_b32 s57, s50, 7
    s_lshl_b32 s58, s55, 6
    s_add_u32 s73, s73, s57
    s_add_u32 s73, s73, s58
    v_and_b32 v248, 31, v0
    v_lshlrev_b32 v248, 10, v248
    v_lshrrev_b32 v249, 5, v0
    v_lshl_add_u32 v248, v249, 4, v248
    s_mov_b32 s70, 400000
    buffer_load_dword v245, v244, s[28:31], 0 offen offset:0 sc1
    v_and_b32 v240, 15, v0
    v_lshrrev_b32 v242, 2, v240
    v_lshrrev_b32 v241, 5, v0
    v_mul_u32_u24 v241, 4, v241
    v_add_u32 v242, v242, v241
    v_lshlrev_b32 v242, 7, v242
    v_and_b32 v241, 3, v240
    v_lshlrev_b32 v241, 3, v241
    v_and_b32 v240, 8, v240
    v_lshlrev_b32 v240, 3, v240
    s_lshl_b32 s57, s55, 6
    v_xor_b32 v240, s57, v240
    v_add_u32 v240, v240, v241
    v_and_b32 v241, 16, v0
    v_lshl_add_u32 v240, v241, 1, v240
    v_add_u32 v242, v242, v240
    v_add_u32 v242, 0, v242
    v_xor_b32 v243, 64, v242
    s_mul_i32 s57, s55, 30720
    s_mul_i32 s58, s55, 49152
    s_add_u32 s58, s58, 61440
    v_add_u32 v14, s58, v242
    v_add_u32 v15, s58, v243
    v_add_u32 v242, s57, v242
    v_add_u32 v243, s57, v243
    s_waitcnt vmcnt(1)
    ds_write_b128 v12, v[16:19] offset:0
    ds_write_b128 v12, v[20:23] offset:1024
    ds_write_b128 v12, v[24:27] offset:2048
    ds_write_b128 v12, v[28:31] offset:3072
    ds_write_b128 v12, v[32:35] offset:4096
    ds_write_b128 v12, v[36:39] offset:5120
    ds_write_b128 v12, v[40:43] offset:6144
    ds_write_b128 v12, v[44:47] offset:7168
    ds_write_b128 v12, v[48:51] offset:8192
    ds_write_b128 v12, v[52:55] offset:9216
    ds_write_b128 v12, v[56:59] offset:10240
    ds_write_b128 v12, v[60:63] offset:11264
    ds_write_b128 v12, v[64:67] offset:12288
    ds_write_b128 v12, v[68:71] offset:13312
L_fa_21:
    s_waitcnt vmcnt(0)
    v_cmp_ne_u32 vcc, s53, v245
    s_cbranch_vccz L_fa_21_x
    s_sub_u32 s70, s70, 1
    s_cbranch_scc1 L_fa_21_x
    buffer_load_dword v245, v244, s[28:31], 0 offen offset:0 sc1
    s_branch L_fa_21
L_fa_21_x:
    buffer_load_dwordx4 v[112:115], v1, s[28:31], s72 offen offset:0 sc1
    buffer_load_dwordx4 v[116:119], v1, s[28:31], s72 offen offset:1024 sc1
    buffer_load_dwordx4 v[120:123], v1, s[28:31], s72 offen offset:2048 sc1
    buffer_load_dwordx4 v[124:127], v1, s[28:31], s72 offen offset:3072 sc1
    s_add_u32 s72, s72, 4096
    buffer_load_dwordx4 v[128:131], v1, s[28:31], s72 offen offset:0 sc1
    buffer_load_dwordx4 v[132:135], v1, s[28:31], s72 offen offset:1024 sc1
    s_waitcnt lgkmcnt(0)
    v_lshlrev_b32 v16, 16, v4
    v_and_b32 v17, 0xffff0000, v4
    v_lshlrev_b32 v18, 16, v5
    v_and_b32 v19, 0xffff0000, v5
    v_lshlrev_b32 v20, 16, v6
    v_and_b32 v21, 0xffff0000, v6
    v_lshlrev_b32 v22, 16, v7
    v_and_b32 v23, 0xffff0000, v7
    v_lshlrev_b32 v24, 16, v8
    v_and_b32 v25, 0xffff0000, v8
    v_lshlrev_b32 v26, 16, v9
    v_and_b32 v27, 0xffff0000, v9
    v_lshlrev_b32 v28, 16, v10
    v_and_b32 v29, 0xffff0000, v10
    v_lshlrev_b32 v30, 16, v11
    v_and_b32 v31, 0xffff0000, v11
    ds_read_b64_tr_b16 v[48:49], v242 offset:0
    ds_read_b64_tr_b16 v[50:51], v242 offset:1024
    ds_read_b64_tr_b16 v[52:53], v243 offset:0
    ds_read_b64_tr_b16 v[54:55], v243 offset:1024
    ds_read_b64_tr_b16 v[56:57], v242 offset:2048
    ds_read_b64_tr_b16 v[58:59], v242 offset:3072
    ds_read_b64_tr_b16 v[60:61], v243 offset:2048
    ds_read_b64_tr_b16 v[62:63], v243 offset:3072
    s_waitcnt vmcnt(5) lgkmcnt(4)
    v_mfma_f32_32x32x16_bf16 v[16:31], v[48:51], v[112:115], v[16:31]
    ds_read_b64_tr_b16 v[64:65], v242 offset:4096
    ds_read_b64_tr_b16 v[66:67], v242 offset:5120
    v_mfma_f32_32x32x16_bf16 v[32:47], v[52:55], v[112:115], 0
    ds_read_b64_tr_b16 v[68:69], v243 offset:4096
    ds_read_b64_tr_b16 v[70:71], v243 offset:5120
    buffer_load_dwordx4 v[136:139], v1, s[28:31], s72 offen offset:2048 sc1
    buffer_load_dwordx4 v[140:143], v1, s[28:31], s72 offen offset:3072 sc1
    ds_write_b128 v12, v[72:75] offset:14336
    s_waitcnt vmcnt(6) lgkmcnt(4)
    v_mfma_f32_32x32x16_bf16 v[16:31], v[56:59], v[116:119], v[16:31]
    ds_read_b64_tr_b16 v[48:49], v242 offset:6144
    ds_read_b64_tr_b16 v[50:51], v242 offset:7168
    v_mfma_f32_32x32x16_bf16 v[32:47], v[60:63], v[116:119], v[32:47]
    ds_read_b64_tr_b16 v[52:53], v243 offset:6144
    ds_read_b64_tr_b16 v[54:55], v243 offset:7168
    s_add_u32 s72, s72, 4096
    buffer_load_dwordx4 v[144:147], v1, s[28:31], s72 offen offset:0 sc1
    buffer_load_dwordx4 v[148:151], v1, s[28:31], s72 offen offset:1024 sc1
    ds_write_b128 v12, v[76:79] offset:15360
    s_waitcnt vmcnt(7) lgkmcnt(4)
    v_mfma_f32_32x32x16_bf16 v[16:31], v[64:67], v[120:123], v[16:31]
    ds_read_b64_tr_b16 v[56:57], v242 offset:8192
    ds_read_b64_tr_b16 v[58:59], v242 offset:9216
    v_mfma_f32_32x32x16_bf16 v[32:47], v[68:71], v[120:123], v[32:47]
    ds_read_b64_tr_b16 v[60:61], v243 offset:8192
    ds_read_b64_tr_b16 v[62:63], v243 offset:9216
    buffer_load_dwordx4 v[152:155], v1, s[28:31], s72 offen offset:2048 sc1
    buffer_load_dwordx4 v[156:159], v1, s[28:31], s72 offen offset:3072 sc1
    ds_write_b128 v12, v[80:83] offset:16384
    s_waitcnt vmcnt(8) lgkmcnt(4)
    v_mfma_f32_32x32x16_bf16 v[16:31], v[48:51], v[124:127], v[16:31]
    ds_read_b64_tr_b16 v[64:65], v242 offset:10240
    ds_read_b64_tr_b16 v[66:67], v242 offset:11264
    v_mfma_f32_32x32x16_bf16 v[32:47], v[52:55], v[124:127], v[32:47]
    ds_read_b64_tr_b16 v[68:69], v243 offset:10240
    ds_read_b64_tr_b16 v[70:71], v243 offset:11264
    s_add_u32 s72, s72, 4096
    buffer_load_dwordx4 v[160:163], v1, s[28:31], s72 offen offset:0 sc1
    buffer_load_dwordx4 v[164:167], v1, s[28:31], s72 offen offset:1024 sc1
    ds_write_b128 v12, v[84:87] offset:17408
    s_waitcnt vmcnt(9) lgkmcnt(4)
    v_mfma_f32_32x32x16_bf16 v[16:31], v[56:59], v[128:131], v[16:31]
    ds_read_b64_tr_b16 v[48:49], v242 offset:12288
    ds_read_b64_tr_b16 v[50:51], v242 offset:13312
    v_mfma_f32_32x32x16_bf16 v[32:47], v[60:63], v[128:131], v[32:47]
    ds_read_b64_tr_b16 v[52:53], v243 offset:12288
    ds_read_b64_tr_b16 v[54:55], v243 offset:13312
    buffer_load_dwordx4 v[168:171], v1, s[28:31], s72 offen offset:2048 sc1
    buffer_load_dwordx4 v[172:175], v1, s[28:31], s72 offen offset:3072 sc1
    ds_write_b128 v12, v[88:91] offset:18432
    s_waitcnt vmcnt(10) lgkmcnt(4)
    v_mfma_f32_32x32x16_bf16 v[16:31], v[64:67], v[132:135], v[16:31]
    ds_read_b64_tr_b16 v[56:57], v242 offset:14336
    ds_read_b64_tr_b16 v[58:59], v242 offset:15360
    v_mfma_f32_32x32x16_bf16 v[32:47], v[68:71], v[132:135], v[32:47]
    ds_read_b64_tr_b16 v[60:61], v243 offset:14336
    ds_read_b64_tr_b16 v[62:63], v243 offset:15360
    s_add_u32 s72, s72, 4096
    buffer_load_dwordx4 v[176:179], v1, s[28:31], s72 offen offset:0 sc1
    buffer_load_dwordx4 v[180:183], v1, s[28:31], s72 offen offset:1024 sc1
    ds_write_b128 v12, v[92:95] offset:19456
    s_waitcnt vmcnt(11) lgkmcnt(4)
    v_mfma_f32_32x32x16_bf16 v[16:31], v[48:51], v[136:139], v[16:31]
    ds_read_b64_tr_b16 v[64:65], v242 offset:16384
    ds_read_b64_tr_b16 v[66:67], v242 offset:17408
    v_mfma_f32_32x32x16_bf16 v[32:47], v[52:55], v[136:139], v[32:47]
    ds_read_b64_tr_b16 v[68:69], v243 offset:16384
    ds_read_b64_tr_b16 v[70:71], v243 offset:17408
    buffer_load_dwordx4 v[184:187], v1, s[28:31], s72 offen offset:2048 sc1
    buffer_load_dwordx4 v[188:191], v1, s[28:31], s72 offen offset:3072 sc1
    ds_write_b128 v12, v[96:99] offset:20480
    s_waitcnt vmcnt(12) lgkmcnt(4)
    v_mfma_f32_32x32x16_bf16 v[16:31], v[56:59], v[140:143], v[16:31]
    ds_read_b64_tr_b16 v[48:49], v242 offset:18432
    ds_read_b64_tr_b16 v[50:51], v242 offset:19456
    v_mfma_f32_32x32x16_bf16 v[32:47], v[60:63], v[140:143], v[32:47]
    ds_read_b64_tr_b16 v[52:53], v243 offset:18432
    ds_read_b64_tr_b16 v[54:55], v243 offset:19456
    s_add_u32 s72, s72, 4096
    buffer_load_dwordx4 v[192:195], v1, s[28:31], s72 offen offset:0 sc1
    buffer_load_dwordx4 v[196:199], v1, s[28:31], s72 offen offset:1024 sc1
    ds_write_b128 v12, v[100:103] offset:21504
    s_waitcnt vmcnt(13) lgkmcnt(4)
    v_mfma_f32_32x32x16_bf16 v[16:31], v[64:67], v[144:147], v[16:31]
    ds_read_b64_tr_b16 v[56:57], v242 offset:20480
    ds_read_b64_tr_b16 v[58:59], v242 offset:21504
    v_mfma_f32_32x32x16_bf16 v[32:47], v[68:71], v[144:147], v[32:47]
    ds_read_b64_tr_b16 v[60:61], v243 offset:20480
    ds_read_b64_tr_b16 v[62:63], v243 offset:21504
    buffer_load_dwordx4 v[200:203], v1, s[28:31], s72 offen offset:2048 sc1
    ds_write_b128 v12, v[104:107] offset:22528
    s_waitcnt vmcnt(13) lgkmcnt(4)
    v_mfma_f32_32x32x16_bf16 v[16:31], v[48:51], v[148:151], v[16:31]
    ds_read_b64_tr_b16 v[64:65], v242 offset:22528
    ds_read_b64_tr_b16 v[66:67], v242 offset:23552
    v_mfma_f32_32x32x16_bf16 v[32:47], v[52:55], v[148:151], v[32:47]
    ds_read_b64_tr_b16 v[68:69], v243 offset:22528
    ds_read_b64_tr_b16 v[70:71], v243 offset:23552
    buffer_load_dwordx4 v[204:207], v1, s[28:31], s72 offen offset:3072 sc1
    ds_write_b128 v12, v[108:111] offset:23552
    s_waitcnt vmcnt(13) lgkmcnt(4)
    v_mfma_f32_32x32x16_bf16 v[16:31], v[56:59], v[152:155], v[16:31]
    ds_read_b64_tr_b16 v[48:49], v242 offset:24576
    ds_read_b64_tr_b16 v[50:51], v242 offset:25600
    v_mfma_f32_32x32x16_bf16 v[32:47], v[60:63], v[152:155], v[32:47]
    ds_read_b64_tr_b16 v[52:53], v243 offset:24576
    ds_read_b64_tr_b16 v[54:55], v243 offset:25600
    s_add_u32 s72, s72, 4096
    buffer_load_dwordx4 v[208:211], v1, s[28:31], s72 offen offset:0 sc1
    s_waitcnt vmcnt(13) lgkmcnt(4)
    v_mfma_f32_32x32x16_bf16 v[16:31], v[64:67], v[156:159], v[16:31]
    ds_read_b64_tr_b16 v[56:57], v242 offset:26624
    ds_read_b64_tr_b16 v[58:59], v242 offset:27648
    v_mfma_f32_32x32x16_bf16 v[32:47], v[68:71], v[156:159], v[32:47]
    ds_read_b64_tr_b16 v[60:61], v243 offset:26624
    ds_read_b64_tr_b16 v[62:63], v243 offset:27648
    buffer_load_dwordx4 v[212:215], v1, s[28:31], s72 offen offset:1024 sc1
    s_waitcnt vmcnt(13) lgkmcnt(4)
    v_mfma_f32_32x32x16_bf16 v[16:31], v[48:51], v[160:163], v[16:31]
    ds_read_b64_tr_b16 v[64:65], v242 offset:28672
    ds_read_b64_tr_b16 v[66:67], v242 offset:29696
    v_mfma_f32_32x32x16_bf16 v[32:47], v[52:55], v[160:163], v[32:47]
    ds_read_b64_tr_b16 v[68:69], v243 offset:28672
    ds_read_b64_tr_b16 v[70:71], v243 offset:29696
    buffer_load_dwordx4 v[216:219], v1, s[28:31], s72 offen offset:2048 sc1
    s_barrier
    s_waitcnt vmcnt(13) lgkmcnt(4)
    v_mfma_f32_32x32x16_bf16 v[16:31], v[56:59], v[164:167], v[16:31]
    ds_read_b64_tr_b16 v[48:49], v14 offset:0
    ds_read_b64_tr_b16 v[50:51], v14 offset:1024
    v_mfma_f32_32x32x16_bf16 v[32:47], v[60:63], v[164:167], v[32:47]
    ds_read_b64_tr_b16 v[52:53], v15 offset:0
    ds_read_b64_tr_b16 v[54:55], v15 offset:1024
    buffer_load_dwordx4 v[220:223], v1, s[28:31], s72 offen offset:3072 sc1
    s_waitcnt vmcnt(13) lgkmcnt(4)
    v_mfma_f32_32x32x16_bf16 v[16:31], v[64:67], v[168:171], v[16:31]
    ds_read_b64_tr_b16 v[56:57], v14 offset:2048
    ds_read_b64_tr_b16 v[58:59], v14 offset:3072
    v_mfma_f32_32x32x16_bf16 v[32:47], v[68:71], v[168:171], v[32:47]
    ds_read_b64_tr_b16 v[60:61], v15 offset:2048
    ds_read_b64_tr_b16 v[62:63], v15 offset:3072
    s_add_u32 s72, s72, 4096
    buffer_load_dwordx4 v[224:227], v1, s[28:31], s72 offen offset:0 sc1
    s_waitcnt vmcnt(13) lgkmcnt(4)
    v_mfma_f32_32x32x16_bf16 v[16:31], v[48:51], v[172:175], v[16:31]
    ds_read_b64_tr_b16 v[64:65], v14 offset:4096
    ds_read_b64_tr_b16 v[66:67], v14 offset:5120
    v_mfma_f32_32x32x16_bf16 v[32:47], v[52:55], v[172:175], v[32:47]
    ds_read_b64_tr_b16 v[68:69], v15 offset:4096
    ds_read_b64_tr_b16 v[70:71], v15 offset:5120
    buffer_load_dwordx4 v[228:231], v1, s[28:31], s72 offen offset:1024 sc1
    s_waitcnt vmcnt(13) lgkmcnt(4)
    v_mfma_f32_32x32x16_bf16 v[16:31], v[56:59], v[176:179], v[16:31]
    ds_read_b64_tr_b16 v[48:49], v14 offset:6144
    ds_read_b64_tr_b16 v[50:51], v14 offset:7168
    v_mfma_f32_32x32x16_bf16 v[32:47], v[60:63], v[176:179], v[32:47]
    ds_read_b64_tr_b16 v[52:53], v15 offset:6144
    ds_read_b64_tr_b16 v[54:55], v15 offset:7168
    buffer_load_dwordx4 v[232:235], v1, s[28:31], s72 offen offset:2048 sc1
    s_waitcnt vmcnt(13) lgkmcnt(4)
    v_mfma_f32_32x32x16_bf16 v[16:31], v[64:67], v[180:183], v[16:31]
    ds_read_b64_tr_b16 v[56:57], v14 offset:8192
    ds_read_b64_tr_b16 v[58:59], v14 offset:9216
    v_mfma_f32_32x32x16_bf16 v[32:47], v[68:71], v[180:183], v[32:47]
    ds_read_b64_tr_b16 v[60:61], v15 offset:8192
    ds_read_b64_tr_b16 v[62:63], v15 offset:9216
    buffer_load_dwordx4 v[236:239], v1, s[28:31], s72 offen offset:3072 sc1
    s_waitcnt vmcnt(13) lgkmcnt(4)
    v_mfma_f32_32x32x16_bf16 v[16:31], v[48:51], v[184:187], v[16:31]
    ds_read_b64_tr_b16 v[64:65], v14 offset:10240
    ds_read_b64_tr_b16 v[66:67], v14 offset:11264
    v_mfma_f32_32x32x16_bf16 v[32:47], v[52:55], v[184:187], v[32:47]
    ds_read_b64_tr_b16 v[68:69], v15 offset:10240
    ds_read_b64_tr_b16 v[70:71], v15 offset:11264
    s_add_u32 s72, s72, 4096
    buffer_load_dwordx4 v[112:115], v1, s[28:31], s72 offen offset:0 sc1
    s_waitcnt vmcnt(13) lgkmcnt(4)
    v_mfma_f32_32x32x16_bf16 v[16:31], v[56:59], v[188:191], v[16:31]
    ds_read_b64_tr_b16 v[48:49], v14 offset:12288
    ds_read_b64_tr_b16 v[50:51], v14 offset:13312
    v_mfma_f32_32x32x16_bf16 v[32:47], v[60:63], v[188:191], v[32:47]
    ds_read_b64_tr_b16 v[52:53], v15 offset:12288
    ds_read_b64_tr_b16 v[54:55], v15 offset:13312
    buffer_load_dwordx4 v[116:119], v1, s[28:31], s72 offen offset:1024 sc1
    s_waitcnt vmcnt(13) lgkmcnt(4)
    v_mfma_f32_32x32x16_bf16 v[16:31], v[64:67], v[192:195], v[16:31]
    ds_read_b64_tr_b16 v[56:57], v14 offset:14336
    ds_read_b64_tr_b16 v[58:59], v14 offset:15360
    v_mfma_f32_32x32x16_bf16 v[32:47], v[68:71], v[192:195], v[32:47]
    ds_read_b64_tr_b16 v[60:61], v15 offset:14336
    ds_read_b64_tr_b16 v[62:63], v15 offset:15360
    buffer_load_dwordx4 v[120:123], v1, s[28:31], s72 offen offset:2048 sc1
    s_waitcnt vmcnt(13) lgkmcnt(4)
    v_mfma_f32_32x32x16_bf16 v[16:31], v[48:51], v[196:199], v[16:31]
    ds_read_b64_tr_b16 v[64:65], v14 offset:16384
    ds_read_b64_tr_b16 v[66:67], v14 offset:17408
    v_mfma_f32_32x32x16_bf16 v[32:47], v[52:55], v[196:199], v[32:47]
    ds_read_b64_tr_b16 v[68:69], v15 offset:16384
    ds_read_b64_tr_b16 v[70:71], v15 offset:17408
    buffer_load_dwordx4 v[124:127], v1, s[28:31], s72 offen offset:3072 sc1
    s_waitcnt vmcnt(13) lgkmcnt(4)
    v_mfma_f32_32x32x16_bf16 v[16:31], v[56:59], v[200:203], v[16:31]
    ds_read_b64_tr_b16 v[48:49], v14 offset:18432
    ds_read_b64_tr_b16 v[50:51], v14 offset:19456
    v_mfma_f32_32x32x16_bf16 v[32:47], v[60:63], v[200:203], v[32:47]
    ds_read_b64_tr_b16 v[52:53], v15 offset:18432
    ds_read_b64_tr_b16 v[54:55], v15 offset:19456
    s_add_u32 s72, s72, 4096
    buffer_load_dwordx4 v[128:131], v1, s[28:31], s72 offen offset:0 sc1
    s_waitcnt vmcnt(13) lgkmcnt(4)
    v_mfma_f32_32x32x16_bf16 v[16:31], v[64:67], v[204:207], v[16:31]
    ds_read_b64_tr_b16 v[56:57], v14 offset:20480
    ds_read_b64_tr_b16 v[58:59], v14 offset:21504
    v_mfma_f32_32x32x16_bf16 v[32:47], v[68:71], v[204:207], v[32:47]
    ds_read_b64_tr_b16 v[60:61], v15 offset:20480
    ds_read_b64_tr_b16 v[62:63], v15 offset:21504
    buffer_load_dwordx4 v[132:135], v1, s[28:31], s72 offen offset:1024 sc1
    s_waitcnt vmcnt(13) lgkmcnt(4)
    v_mfma_f32_32x32x16_bf16 v[16:31], v[48:51], v[208:211], v[16:31]
    ds_read_b64_tr_b16 v[64:65], v14 offset:22528
    ds_read_b64_tr_b16 v[66:67], v14 offset:23552
    v_mfma_f32_32x32x16_bf16 v[32:47], v[52:55], v[208:211], v[32:47]
    ds_read_b64_tr_b16 v[68:69], v15 offset:22528
    ds_read_b64_tr_b16 v[70:71], v15 offset:23552
    buffer_load_dwordx4 v[136:139], v1, s[28:31], s72 offen offset:2048 sc1
    s_waitcnt vmcnt(13) lgkmcnt(4)
    v_mfma_f32_32x32x16_bf16 v[16:31], v[56:59], v[212:215], v[16:31]
    ds_read_b64_tr_b16 v[48:49], v14 offset:24576
    ds_read_b64_tr_b16 v[50:51], v14 offset:25600
    v_mfma_f32_32x32x16_bf16 v[32:47], v[60:63], v[212:215], v[32:47]
    ds_read_b64_tr_b16 v[52:53], v15 offset:24576
    ds_read_b64_tr_b16 v[54:55], v15 offset:25600
    buffer_load_dwordx4 v[140:143], v1, s[28:31], s72 offen offset:3072 sc1
    s_waitcnt vmcnt(13) lgkmcnt(4)
    v_mfma_f32_32x32x16_bf16 v[16:31], v[64:67], v[216:219], v[16:31]
    ds_read_b64_tr_b16 v[56:57], v14 offset:26624
    ds_read_b64_tr_b16 v[58:59], v14 offset:27648
    v_mfma_f32_32x32x16_bf16 v[32:47], v[68:71], v[216:219], v[32:47]
    ds_read_b64_tr_b16 v[60:61], v15 offset:26624
    ds_read_b64_tr_b16 v[62:63], v15 offset:27648
    s_add_u32 s72, s72, 4096
    buffer_load_dwordx4 v[144:147], v1, s[28:31], s72 offen offset:0 sc1
    s_waitcnt vmcnt(13) lgkmcnt(4)
    v_mfma_f32_32x32x16_bf16 v[16:31], v[48:51], v[220:223], v[16:31]
    ds_read_b64_tr_b16 v[64:65], v14 offset:28672
    ds_read_b64_tr_b16 v[66:67], v14 offset:29696
    v_mfma_f32_32x32x16_bf16 v[32:47], v[52:55], v[220:223], v[32:47]
    ds_read_b64_tr_b16 v[68:69], v15 offset:28672
    ds_read_b64_tr_b16 v[70:71], v15 offset:29696
    buffer_load_dwordx4 v[148:151], v1, s[28:31], s72 offen offset:1024 sc1
    s_waitcnt vmcnt(13) lgkmcnt(4)
    v_mfma_f32_32x32x16_bf16 v[16:31], v[56:59], v[224:227], v[16:31]
    ds_read_b64_tr_b16 v[48:49], v14 offset:30720
    ds_read_b64_tr_b16 v[50:51], v14 offset:31744
    v_mfma_f32_32x32x16_bf16 v[32:47], v[60:63], v[224:227], v[32:47]
    ds_read_b64_tr_b16 v[52:53], v15 offset:30720
    ds_read_b64_tr_b16 v[54:55], v15 offset:31744
    buffer_load_dwordx4 v[152:155], v1, s[28:31], s72 offen offset:2048 sc1
    s_waitcnt vmcnt(13) lgkmcnt(4)
    v_mfma_f32_32x32x16_bf16 v[16:31], v[64:67], v[228:231], v[16:31]
    ds_read_b64_tr_b16 v[56:57], v14 offset:32768
    ds_read_b64_tr_b16 v[58:59], v14 offset:33792
    v_mfma_f32_32x32x16_bf16 v[32:47], v[68:71], v[228:231], v[32:47]
    ds_read_b64_tr_b16 v[60:61], v15 offset:32768
    ds_read_b64_tr_b16 v[62:63], v15 offset:33792
    s_waitcnt vmcnt(12) lgkmcnt(4)
    v_mfma_f32_32x32x16_bf16 v[16:31], v[48:51], v[232:235], v[16:31]
    ds_read_b64_tr_b16 v[64:65], v14 offset:34816
    ds_read_b64_tr_b16 v[66:67], v14 offset:35840
    v_mfma_f32_32x32x16_bf16 v[32:47], v[52:55], v[232:235], v[32:47]
    ds_read_b64_tr_b16 v[68:69], v15 offset:34816
    ds_read_b64_tr_b16 v[70:71], v15 offset:35840
    s_barrier
    s_waitcnt vmcnt(11) lgkmcnt(4)
    v_mfma_f32_32x32x16_bf16 v[16:31], v[56:59], v[236:239], v[16:31]
    ds_read_b64_tr_b16 v[48:49], v14 offset:36864
    ds_read_b64_tr_b16 v[50:51], v14 offset:37888
    v_mfma_f32_32x32x16_bf16 v[32:47], v[60:63], v[236:239], v[32:47]
    ds_read_b64_tr_b16 v[52:53], v15 offset:36864
    ds_read_b64_tr_b16 v[54:55], v15 offset:37888
    s_waitcnt vmcnt(10) lgkmcnt(4)
    v_mfma_f32_32x32x16_bf16 v[16:31], v[64:67], v[112:115], v[16:31]
    ds_read_b64_tr_b16 v[56:57], v14 offset:38912
    ds_read_b64_tr_b16 v[58:59], v14 offset:39936
    v_mfma_f32_32x32x16_bf16 v[32:47], v[68:71], v[112:115], v[32:47]
    ds_read_b64_tr_b16 v[60:61], v15 offset:38912
    ds_read_b64_tr_b16 v[62:63], v15 offset:39936
    s_waitcnt vmcnt(9) lgkmcnt(4)
    v_mfma_f32_32x32x16_bf16 v[16:31], v[48:51], v[116:119], v[16:31]
    ds_read_b64_tr_b16 v[64:65], v14 offset:40960
    ds_read_b64_tr_b16 v[66:67], v14 offset:41984
    v_mfma_f32_32x32x16_bf16 v[32:47], v[52:55], v[116:119], v[32:47]
    ds_read_b64_tr_b16 v[68:69], v15 offset:40960
    ds_read_b64_tr_b16 v[70:71], v15 offset:41984
    s_waitcnt vmcnt(8) lgkmcnt(4)
    v_mfma_f32_32x32x16_bf16 v[16:31], v[56:59], v[120:123], v[16:31]
    ds_read_b64_tr_b16 v[48:49], v14 offset:43008
    ds_read_b64_tr_b16 v[50:51], v14 offset:44032
    v_mfma_f32_32x32x16_bf16 v[32:47], v[60:63], v[120:123], v[32:47]
    ds_read_b64_tr_b16 v[52:53], v15 offset:43008
    ds_read_b64_tr_b16 v[54:55], v15 offset:44032
    s_waitcnt vmcnt(7) lgkmcnt(4)
    v_mfma_f32_32x32x16_bf16 v[16:31], v[64:67], v[124:127], v[16:31]
    ds_read_b64_tr_b16 v[56:57], v14 offset:45056
    ds_read_b64_tr_b16 v[58:59], v14 offset:46080
    v_mfma_f32_32x32x16_bf16 v[32:47], v[68:71], v[124:127], v[32:47]
    ds_read_b64_tr_b16 v[60:61], v15 offset:45056
    ds_read_b64_tr_b16 v[62:63], v15 offset:46080
    s_waitcnt vmcnt(6) lgkmcnt(4)
    v_mfma_f32_32x32x16_bf16 v[16:31], v[48:51], v[128:131], v[16:31]
    ds_read_b64_tr_b16 v[64:65], v14 offset:47104
    ds_read_b64_tr_b16 v[66:67], v14 offset:48128
    v_mfma_f32_32x32x16_bf16 v[32:47], v[52:55], v[128:131], v[32:47]
    ds_read_b64_tr_b16 v[68:69], v15 offset:47104
    ds_read_b64_tr_b16 v[70:71], v15 offset:48128
    s_waitcnt vmcnt(5) lgkmcnt(4)
    v_mfma_f32_32x32x16_bf16 v[16:31], v[56:59], v[132:135], v[16:31]
    ds_read_b64_tr_b16 v[48:49], v242 offset:0
    ds_read_b64_tr_b16 v[50:51], v242 offset:1024
    v_mfma_f32_32x32x16_bf16 v[32:47], v[60:63], v[132:135], v[32:47]
    ds_read_b64_tr_b16 v[52:53], v243 offset:0
    ds_read_b64_tr_b16 v[54:55], v243 offset:1024
    s_waitcnt vmcnt(4) lgkmcnt(4)
    v_mfma_f32_32x32x16_bf16 v[16:31], v[64:67], v[136:139], v[16:31]
    ds_read_b64_tr_b16 v[56:57], v242 offset:2048
    ds_read_b64_tr_b16 v[58:59], v242 offset:3072
    v_mfma_f32_32x32x16_bf16 v[32:47], v[68:71], v[136:139], v[32:47]
    ds_read_b64_tr_b16 v[60:61], v243 offset:2048
    ds_read_b64_tr_b16 v[62:63], v243 offset:3072
    s_waitcnt vmcnt(3) lgkmcnt(4)
    v_mfma_f32_32x32x16_bf16 v[16:31], v[48:51], v[140:143], v[16:31]
    ds_read_b64_tr_b16 v[64:65], v242 offset:4096
    ds_read_b64_tr_b16 v[66:67], v242 offset:5120
    v_mfma_f32_32x32x16_bf16 v[32:47], v[52:55], v[140:143], v[32:47]
    ds_read_b64_tr_b16 v[68:69], v243 offset:4096
    ds_read_b64_tr_b16 v[70:71], v243 offset:5120
    s_waitcnt vmcnt(2) lgkmcnt(4)
    v_mfma_f32_32x32x16_bf16 v[16:31], v[56:59], v[144:147], v[16:31]
    ds_read_b64_tr_b16 v[48:49], v242 offset:6144
    ds_read_b64_tr_b16 v[50:51], v242 offset:7168
    v_mfma_f32_32x32x16_bf16 v[32:47], v[60:63], v[144:147], v[32:47]
    ds_read_b64_tr_b16 v[52:53], v243 offset:6144
    ds_read_b64_tr_b16 v[54:55], v243 offset:7168
    s_waitcnt vmcnt(1) lgkmcnt(4)
    v_mfma_f32_32x32x16_bf16 v[16:31], v[64:67], v[148:151], v[16:31]
    v_mfma_f32_32x32x16_bf16 v[32:47], v[68:71], v[148:151], v[32:47]
    s_waitcnt vmcnt(0) lgkmcnt(0)
    v_mfma_f32_32x32x16_bf16 v[16:31], v[48:51], v[152:155], v[16:31]
    v_mfma_f32_32x32x16_bf16 v[32:47], v[52:55], v[152:155], v[32:47]
    s_nop 7
    s_nop 3
    ds_write_b128 v246, v[32:35] offset:0
    ds_write_b128 v246, v[36:39] offset:1024
    ds_write_b128 v246, v[40:43] offset:2048
    ds_write_b128 v246, v[44:47] offset:3072
    s_waitcnt lgkmcnt(0)
    s_barrier
    ds_read_b128 v[32:35], v247 offset:0
    ds_read_b128 v[36:39], v247 offset:1024
    ds_read_b128 v[40:43], v247 offset:2048
    ds_read_b128 v[44:47], v247 offset:3072
    s_waitcnt lgkmcnt(3)
    v_add_f32 v16, v16, v32
    v_add_f32 v17, v17, v33
    v_add_f32 v18, v18, v34
    v_add_f32 v19, v19, v35
    s_waitcnt lgkmcnt(2)
    v_add_f32 v20, v20, v36
    v_add_f32 v21, v21, v37
    v_add_f32 v22, v22, v38
    v_add_f32 v23, v23, v39
    s_waitcnt lgkmcnt(1)
    v_add_f32 v24, v24, v40
    v_add_f32 v25, v25, v41
    v_add_f32 v26, v26, v42
    v_add_f32 v27, v27, v43
    s_waitcnt lgkmcnt(0)
    v_add_f32 v28, v28, v44
    v_add_f32 v29, v29, v45
    v_add_f32 v30, v30, v46
    v_add_f32 v31, v31, v47
    v_cvt_pk_bf16_f32 v4, v16, v17
    v_cvt_pk_bf16_f32 v5, v18, v19
    v_cvt_pk_bf16_f32 v6, v20, v21
    v_cvt_pk_bf16_f32 v7, v22, v23
    v_cvt_pk_bf16_f32 v8, v24, v25
    v_cvt_pk_bf16_f32 v9, v26, v27
    v_cvt_pk_bf16_f32 v10, v28, v29
    v_cvt_pk_bf16_f32 v11, v30, v31
    s_nop 0
    v_permlane32_swap_b32 v4, v6
    v_permlane32_swap_b32 v5, v7
    buffer_store_dwordx4 v[4:7], v248, s[32:35], s73 offen
    v_permlane32_swap_b32 v8, v10
    v_permlane32_swap_b32 v9, v11
    buffer_store_dwordx4 v[8:11], v248, s[32:35], s73 offen offset:32
    s_waitcnt vmcnt(0)
    s_endpgm
.p2align 9
L_g1_e:
    s_lshr_b32 s57, s76, 1
    s_and_b32 s60, s76, 1
    s_lshl_b32 s60, s60, 2
    s_mul_i32 s61, s57, 86
    s_add_u32 s61, s61, s60
    s_add_u32 s61, s61, 78
    s_lshl_b32 s59, s61, 13
    s_lshl_b32 s58, s50, 7
    s_add_u32 s59, s59, s58
    buffer_load_dwordx4 v[84:87], v2, s[36:39], s59 offen
    s_add_u32 s59, s59, 8192
    buffer_load_dwordx4 v[88:91], v2, s[36:39], s59 offen
    s_add_u32 s59, s59, 8192
    buffer_load_dwordx4 v[92:95], v2, s[36:39], s59 offen
    s_add_u32 s59, s59, 8192
    buffer_load_dwordx4 v[96:99], v2, s[36:39], s59 offen
    s_lshr_b32 s57, s76, 1
    s_and_b32 s60, s76, 1
    s_lshl_b32 s60, s60, 2
    s_mul_i32 s61, s57, 30
    s_add_u32 s61, s61, s60
    s_lshl_b32 s61, s61, 10
    v_add_u32 v13, s61, v1
    s_waitcnt vmcnt(0)
    s_barrier
    ds_write_b128 v13, v[84:87] offset:0
    ds_write_b128 v13, v[88:91] offset:1024
    ds_write_b128 v13, v[92:95] offset:2048
    ds_write_b128 v13, v[96:99] offset:3072
    s_waitcnt lgkmcnt(0)
    s_barrier
    s_barrier
L_end:
    s_endpgm
.section .rodata,"a"
.p2align 6
.amdhsa_kernel sequential_preLN__grouped_kv_mqa__geglu_ffn__prompt_kernel
  .amdhsa_next_free_vgpr 256
  .amdhsa_next_free_sgpr 102
  .amdhsa_accum_offset 256
  .amdhsa_group_segment_fixed_size 0
  .amdhsa_kernarg_size 96
  .amdhsa_user_sgpr_count 2
  .amdhsa_user_sgpr_kernarg_segment_ptr 1
  .amdhsa_system_sgpr_workgroup_id_x 1
.end_amdhsa_kernel
```
